```python
import torch

def _softmax(x, axis=-1):
    return torch.softmax(x, dim=axis)

def _gelu(x):
    return torch.nn.functional.gelu(x, approximate='tanh')

def _silu(x):
    return torch.nn.functional.silu(x)

def _sigmoid(x):
    return torch.sigmoid(x)

def _layernorm(x, axis=-1, eps=1e-05):
    m = x.mean(dim=axis, keepdim=True)
    v = x.var(dim=axis, keepdim=True, unbiased=False)
    return (x - m) / torch.sqrt(v + eps)

def _scatter_add(tgt, idx, src, axis=0):
    return tgt.clone().index_add_(axis, idx, src)

def _segment_sum(src, seg, n):
    out = torch.zeros((n,) + src.shape[1:], dtype=src.dtype)
    return out.index_add_(0, seg, src)

def _pad(x, pw):
    flat = tuple((v for pair in reversed(pw) for v in pair))
    return torch.nn.functional.pad(x, flat)
kernel_name = 'adaLN_cond__mha_block_cached__swiglu_ffn__decode'

def setup_inputs():

    _w = lambda a: (lambda t: t.to(torch.bfloat16) if t.is_floating_point() else t)(torch.as_tensor(a))

    def _A_setup():
        B, Sq, D = (1, 1, 576)
        H, Sk, Dh = (32, 8192, 128)
        return {'x': _w((lambda *s: torch.randn(*s, dtype=torch.bfloat16) * 0.05)(B, Sq, D)), 'k_cache': _w((lambda *s: torch.randn(*s, dtype=torch.bfloat16) * 3.2)(B, H, Sk, Dh)), 'v_cache': _w((lambda *s: torch.randn(*s, dtype=torch.bfloat16) * 0.4)(B, H, Sk, Dh)), 'wq': _w((lambda *s: torch.randn(*s, dtype=torch.bfloat16) * 3.2)(D, H * Dh) * D ** (-0.5)), 'wo': _w((lambda *s: torch.randn(*s, dtype=torch.bfloat16) * 0.4)(H * Dh, D) * (H * Dh) ** (-0.5))}
    _A_in = _A_setup()

    def _B_setup():
        B, S, D, F = (1, 1, 576, 4608)
        return {'x': _w((lambda *s: torch.randn(*s, dtype=torch.bfloat16) * 0.05)(B, S, D)), 'w_gate': _w((lambda *s: torch.randn(*s, dtype=torch.bfloat16) * 0.05)(D, F)), 'w_up': _w((lambda *s: torch.randn(*s, dtype=torch.bfloat16) * 0.05)(D, F)), 'w_down': _w((lambda *s: torch.randn(*s, dtype=torch.bfloat16) * 0.05)(F, D))}
    _B_in = _B_setup()
    return {'A_x': _A_in['x'], 'A_k_cache': _A_in['k_cache'], 'A_v_cache': _A_in['v_cache'], 'A_wq': _A_in['wq'], 'A_wo': _A_in['wo'], 'B_x': _B_in['x'], 'B_w_gate': _B_in['w_gate'], 'B_w_up': _B_in['w_up'], 'B_w_down': _B_in['w_down'], 'c': _w((lambda *s: torch.randn(*s, dtype=torch.bfloat16) * 0.1)(1, 576) * 8.0), 'w_mod': _w((lambda *s: torch.randn(*s, dtype=torch.bfloat16) * 0.1)(576, 6 * 576) * 576 ** (-0.5) * 8.0)}

def reference(A_x, A_k_cache, A_v_cache, A_wq, A_wo, B_x, B_w_gate, B_w_up, B_w_down, c, w_mod):

    def _A_ref(x, k_cache, v_cache, wq, wo):
        B, Sq, D = x.shape
        H, Dh = (32, 128)
        q = (lambda x, *d: x.permute(*d))((x @ wq).reshape(B, Sq, H, Dh), 0, 2, 1, 3)
        scores = torch.einsum('bhqd,bhkd->bhqk', q, k_cache) * Dh ** (-0.5)
        p = _softmax(scores, axis=-1)
        o = torch.einsum('bhqk,bhkd->bhqd', p, v_cache)
        return (lambda x, *d: x.permute(*d))(o, 0, 2, 1, 3).reshape(B, Sq, H * Dh) @ wo

    def _B_ref(x, w_gate, w_up, w_down):
        g = _silu(x @ w_gate)
        u = x @ w_up
        return g * u @ w_down
    x = A_x
    mod = (_silu(c) @ w_mod).reshape(c.shape[0], 6, 1, -1)
    sa, ca, ga, sb, cb, gb = (mod[:, 0].clone(), mod[:, 1].clone(), mod[:, 2].clone(), mod[:, 3].clone(), mod[:, 4].clone(), mod[:, 5].clone())
    h = _layernorm(x, axis=-1) * (1 + ca) + sa
    x = x + ga * _A_ref(h, A_k_cache, A_v_cache, A_wq, A_wo)
    h = _layernorm(x, axis=-1) * (1 + cb) + sb
    x = x + gb * _B_ref(h, B_w_gate, B_w_up, B_w_down)
    return x
```

```asm
; @launch grid=(256,1,1) block=(768,1,1) lds=29696
.amdgcn_target "amdgcn-amd-amdhsa--gfx950"
.text
.globl adaLN_cond__mha_block_cached__swiglu_ffn__decode_kernel
.p2align 8
.type adaLN_cond__mha_block_cached__swiglu_ffn__decode_kernel,@function
adaLN_cond__mha_block_cached__swiglu_ffn__decode_kernel:
    s_cmp_ge_u32 s2, 256
    s_cbranch_scc1 L_exit
    s_load_dwordx16 s[16:31], s[0:1], 0
    s_load_dwordx8 s[32:39], s[0:1], 64
    s_load_dwordx4 s[40:43], s[0:1], 96
    v_lshrrev_b32 v2, 6, v0
    v_and_b32 v1, 63, v0
    v_readfirstlane_b32 s3, v2
    s_and_b32 s4, s2, 7
    s_lshr_b32 s5, s2, 3
    s_mov_b32 s56, 0x3020100
    s_mov_b32 s57, 0x7060504
    s_mov_b32 s58, 0xb0a1c08
    s_mov_b32 s59, 0x110f0e0d
    s_mov_b32 s60, 0x16151312
    s_mov_b32 s61, 0x1b1a1917
    s_mov_b32 s62, 0x181f1e1d
    s_mov_b32 s63, 0x914100c
    s_lshr_b32 m0, s5, 2
    s_and_b32 s13, s5, 3
    s_lshl_b32 s13, s13, 3
    s_movrels_b32 s14, s56
    s_lshr_b32 s14, s14, s13
    s_bfe_u32 s7, s14, 0x30002
    s_add_u32 s12, s4, s7
    s_and_b32 s12, s12, 7
    s_lshl_b32 s12, s12, 2
    s_and_b32 s6, s14, 3
    s_add_u32 s6, s6, s12
    s_lshl_b32 s8, s6, 3
    s_add_u32 s8, s8, s7
    s_mov_b32 s72, 0xcccccccc
    s_mov_b32 s73, 0xcccccccc
    s_mov_b32 s74, 0xaaaaaaaa
    s_mov_b32 s75, 0xaaaaaaaa
    s_mov_b32 s76, 0x05040100
    s_mov_b32 s77, 0x07060302
    s_mov_b32 s78, 0xffff0000
    v_mov_b32 v10, 0
    v_mov_b32 v11, 1
    v_lshlrev_b32 v4, 4, v1
    v_lshlrev_b32 v2, 2, v1
    s_cmp_lg_u32 s3, 8
    s_nop 0
    s_cbranch_scc1 L_noinit
    s_mov_b64 exec, 0xff
    ds_write_b32 v2, v10 offset:0
    s_mov_b64 exec, -1
L_noinit:
    s_cmp_ge_u32 s3, 8
    s_cbranch_scc1 L_helper
    s_mov_b32 s56, 0x0
    s_mov_b32 s64, 0xe0e0e0e
    s_mov_b32 s57, 0xe0e0e0e
    s_mov_b32 s65, 0xe0e0e0e
    s_mov_b32 s58, 0x1c1c1c1c
    s_mov_b32 s66, 0x1c1c1e0e
    s_mov_b32 s59, 0x38383a2a
    s_mov_b32 s67, 0x1c1c1c1e
    s_mov_b32 s60, 0x54545648
    s_mov_b32 s68, 0x1c1c1c1e
    s_mov_b32 s61, 0x70707266
    s_mov_b32 s69, 0x1c1c1c1e
    s_mov_b32 s62, 0x8c8c8e84
    s_mov_b32 s70, 0x1d1c1c1d
    s_mov_b32 s63, 0xa9a8aaa1
    s_mov_b32 s71, 0x1d1d1d1c
    s_mov_b32 m0, s7
    s_and_b32 s14, s6, 3
    s_lshl_b32 s14, s14, 3
    s_movrels_b32 s12, s56
    s_movrels_b32 s9, s64
    s_lshr_b32 s12, s12, s14
    s_and_b32 s12, s12, 0xff
    s_lshr_b32 s9, s9, s14
    s_and_b32 s9, s9, 0xff
    s_lshl_b32 s12, s12, 13
    s_lshl_b32 s13, s6, 21
    s_add_u32 s12, s12, s13
    s_lshl_b32 s13, s3, 10
    v_add_u32 v2, s13, v4
    s_lshl_b32 s54, s9, 13
    s_mov_b32 s55, 0x00020000
    s_waitcnt lgkmcnt(0)
    s_barrier
    s_load_dwordx2 s[44:45], s[42:43], 0
    s_add_u32 s52, s18, s12
    s_addc_u32 s53, s19, 0
    s_cmp_lt_u32 s5, 9
    s_cbranch_scc1 L_attF
    s_mov_b32 s11, 0x0
    buffer_load_dwordx4 v[24:27], v2, s[52:55], s11 offen nt
    s_mov_b32 s11, 0x2000
    buffer_load_dwordx4 v[28:31], v2, s[52:55], s11 offen nt
    s_mov_b32 s11, 0x4000
    buffer_load_dwordx4 v[32:35], v2, s[52:55], s11 offen nt
    s_mov_b32 s11, 0x6000
    buffer_load_dwordx4 v[36:39], v2, s[52:55], s11 offen nt
    s_add_u32 s56, s20, s12
    s_addc_u32 s57, s21, 0
    s_mov_b32 s58, s54
    s_mov_b32 s59, s55
    s_mov_b32 s48, s42
    s_mov_b32 s49, s43
    s_mov_b32 s50, 0x400000
    s_mov_b32 s51, 0x00020000
    s_sub_u32 s13, s9, 16
    s_bfm_b32 s60, s13, 0
    s_mul_i32 s60, s60, 0x10001
    s_mov_b32 s61, s60
    v_mov_b32 v16, 0
    v_mov_b32 v17, 0
    v_mov_b32 v18, 0
    v_mov_b32 v19, 0
    v_mov_b32 v20, 0
    v_mov_b32 v21, 0
    v_mov_b32 v22, 0
    v_mov_b32 v23, 0
    v_and_b32 v3, 15, v1
    v_lshlrev_b32 v13, 4, v3
    v_lshlrev_b32 v3, 5, v3
    v_lshrrev_b32 v5, 4, v1
    v_lshl_add_u32 v3, v5, 3, v3
    s_lshl_b32 s12, s3, 9
    v_add_u32 v3, s12, v3
    s_lshl_b32 s15, s8, 9
    s_add_u32 s15, s15, 0x60000
    s_waitcnt vmcnt(3)
    s_mov_b32 s11, 0x8000
    buffer_load_dwordx4 v[40:43], v2, s[52:55], s11 offen nt
    s_waitcnt vmcnt(3)
    s_mov_b32 s11, 0xa000
    buffer_load_dwordx4 v[44:47], v2, s[52:55], s11 offen nt
    s_waitcnt vmcnt(3)
    s_mov_b32 s11, 0xc000
    buffer_load_dwordx4 v[48:51], v2, s[52:55], s11 offen nt
    s_waitcnt vmcnt(3)
    s_mov_b32 s11, 0xe000
    buffer_load_dwordx4 v[52:55], v2, s[52:55], s11 offen nt
    s_waitcnt vmcnt(3)
    s_mov_b32 s11, 0x10000
    buffer_load_dwordx4 v[56:59], v2, s[52:55], s11 offen nt
    s_waitcnt vmcnt(3)
    s_mov_b32 s11, 0x12000
    buffer_load_dwordx4 v[60:63], v2, s[52:55], s11 offen nt
    s_waitcnt vmcnt(3)
    s_mov_b32 s11, 0x14000
    buffer_load_dwordx4 v[64:67], v2, s[52:55], s11 offen nt
    s_waitcnt vmcnt(3)
    s_mov_b32 s11, 0x16000
    buffer_load_dwordx4 v[68:71], v2, s[52:55], s11 offen nt
    s_waitcnt vmcnt(3)
    s_mov_b32 s11, 0x18000
    buffer_load_dwordx4 v[72:75], v2, s[52:55], s11 offen nt
    s_waitcnt vmcnt(3)
    s_mov_b32 s11, 0x1a000
    buffer_load_dwordx4 v[76:79], v2, s[52:55], s11 offen nt
    s_waitcnt vmcnt(3)
    s_mov_b32 s11, 0x1c000
    buffer_load_dwordx4 v[80:83], v2, s[52:55], s11 offen nt
    s_waitcnt vmcnt(3)
    s_mov_b32 s11, 0x1e000
    buffer_load_dwordx4 v[84:87], v2, s[52:55], s11 offen nt
    s_waitcnt vmcnt(3)
    s_mov_b32 s11, 0x20000
    buffer_load_dwordx4 v[88:91], v2, s[52:55], s11 offen nt
    s_waitcnt vmcnt(3)
    s_mov_b32 s11, 0x22000
    buffer_load_dwordx4 v[92:95], v2, s[52:55], s11 offen nt
    s_waitcnt vmcnt(3)
    s_mov_b32 s11, 0x24000
    buffer_load_dwordx4 v[96:99], v2, s[52:55], s11 offen nt
    s_waitcnt vmcnt(3)
    s_mov_b32 s11, 0x26000
    buffer_load_dwordx4 v[100:103], v2, s[52:55], s11 offen nt
    s_waitcnt vmcnt(3)
    s_mov_b32 s11, 0x28000
    buffer_load_dwordx4 v[104:107], v2, s[52:55], s11 offen nt
    s_waitcnt vmcnt(3)
    s_mov_b32 s11, 0x2a000
    buffer_load_dwordx4 v[108:111], v2, s[52:55], s11 offen nt
    s_waitcnt vmcnt(3)
    s_mov_b32 s11, 0x2c000
    buffer_load_dwordx4 v[112:115], v2, s[52:55], s11 offen nt
    s_waitcnt vmcnt(3)
    s_mov_b32 s11, 0x2e000
    buffer_load_dwordx4 v[116:119], v2, s[52:55], s11 offen nt
    s_waitcnt vmcnt(3)
    s_mov_b32 s11, 0x30000
    buffer_load_dwordx4 v[120:123], v2, s[52:55], s11 offen nt
    s_waitcnt vmcnt(3)
    s_mov_b32 s11, 0x32000
    buffer_load_dwordx4 v[124:127], v2, s[52:55], s11 offen nt
    s_waitcnt vmcnt(3)
    s_mov_b32 s11, 0x34000
    buffer_load_dwordx4 v[128:131], v2, s[52:55], s11 offen nt
    s_waitcnt vmcnt(3)
    s_mov_b32 s11, 0x36000
    buffer_load_dwordx4 v[132:135], v2, s[52:55], s11 offen nt
    s_waitcnt vmcnt(3)
    s_mov_b32 s11, 0x38000
    buffer_load_dwordx4 v[136:139], v2, s[52:55], s11 offen nt
    s_waitcnt vmcnt(3)
    s_mov_b32 s11, 0x3a000
    buffer_load_dwordx4 v[140:143], v2, s[52:55], s11 offen nt
    s_waitcnt vmcnt(3)
    s_mov_b32 s11, 0x0
    buffer_load_dwordx4 v[144:147], v2, s[56:59], s11 offen nt
    s_waitcnt vmcnt(3)
    s_mov_b32 s11, 0x2000
    buffer_load_dwordx4 v[148:151], v2, s[56:59], s11 offen nt
    s_waitcnt vmcnt(3)
    s_mov_b32 s11, 0x4000
    buffer_load_dwordx4 v[152:155], v2, s[56:59], s11 offen nt
    s_waitcnt vmcnt(3)
    s_mov_b32 s11, 0x6000
    buffer_load_dwordx4 v[156:159], v2, s[56:59], s11 offen nt
    s_waitcnt vmcnt(3)
    s_mov_b32 s11, 0x8000
    buffer_load_dwordx4 v[160:163], v2, s[56:59], s11 offen nt
    s_waitcnt vmcnt(3)
    s_mov_b32 s11, 0xa000
    buffer_load_dwordx4 v[164:167], v2, s[56:59], s11 offen nt
    s_waitcnt lgkmcnt(0)
    s_add_u32 s44, s44, 0x7f4a7c15
    s_addc_u32 s45, s45, 0x9e3779b9
L_fw_1:
    ds_read_b32 v12, v10 offset:0
    s_waitcnt lgkmcnt(0)
    v_readfirstlane_b32 s12, v12
    s_nop 0
    s_cmp_lg_u32 s12, 0
    s_nop 1
    s_cbranch_scc1 L_fwd_2
    s_sleep 2
    s_branch L_fw_1
L_fwd_2:
    ds_read_b128 v[12:15], v13 offset:64
    s_waitcnt lgkmcnt(0)
    v_dot2_f32_bf16 v24, v24, v12, 0
    v_dot2_f32_bf16 v28, v28, v12, 0
    v_dot2_f32_bf16 v32, v32, v12, 0
    v_dot2_f32_bf16 v36, v36, v12, 0
    v_dot2_f32_bf16 v24, v25, v13, v24
    v_dot2_f32_bf16 v28, v29, v13, v28
    v_dot2_f32_bf16 v32, v33, v13, v32
    v_dot2_f32_bf16 v36, v37, v13, v36
    v_dot2_f32_bf16 v24, v26, v14, v24
    v_dot2_f32_bf16 v28, v30, v14, v28
    v_dot2_f32_bf16 v32, v34, v14, v32
    v_dot2_f32_bf16 v36, v38, v14, v36
    v_dot2_f32_bf16 v24, v27, v15, v24
    v_dot2_f32_bf16 v28, v31, v15, v28
    v_dot2_f32_bf16 v32, v35, v15, v32
    v_dot2_f32_bf16 v36, v39, v15, v36
    v_dot2_f32_bf16 v40, v40, v12, 0
    v_dot2_f32_bf16 v44, v44, v12, 0
    v_dot2_f32_bf16 v48, v48, v12, 0
    v_dot2_f32_bf16 v52, v52, v12, 0
    v_dot2_f32_bf16 v40, v41, v13, v40
    v_dot2_f32_bf16 v44, v45, v13, v44
    v_dot2_f32_bf16 v48, v49, v13, v48
    v_dot2_f32_bf16 v52, v53, v13, v52
    v_dot2_f32_bf16 v40, v42, v14, v40
    v_dot2_f32_bf16 v44, v46, v14, v44
    v_dot2_f32_bf16 v48, v50, v14, v48
    v_dot2_f32_bf16 v52, v54, v14, v52
    v_dot2_f32_bf16 v40, v43, v15, v40
    v_dot2_f32_bf16 v44, v47, v15, v44
    v_dot2_f32_bf16 v48, v51, v15, v48
    v_dot2_f32_bf16 v52, v55, v15, v52
    v_dot2_f32_bf16 v56, v56, v12, 0
    v_dot2_f32_bf16 v60, v60, v12, 0
    v_dot2_f32_bf16 v64, v64, v12, 0
    v_dot2_f32_bf16 v68, v68, v12, 0
    v_dot2_f32_bf16 v56, v57, v13, v56
    v_dot2_f32_bf16 v60, v61, v13, v60
    v_dot2_f32_bf16 v64, v65, v13, v64
    v_dot2_f32_bf16 v68, v69, v13, v68
    v_dot2_f32_bf16 v56, v58, v14, v56
    v_dot2_f32_bf16 v60, v62, v14, v60
    v_dot2_f32_bf16 v64, v66, v14, v64
    v_dot2_f32_bf16 v68, v70, v14, v68
    v_dot2_f32_bf16 v56, v59, v15, v56
    v_dot2_f32_bf16 v60, v63, v15, v60
    v_dot2_f32_bf16 v64, v67, v15, v64
    v_dot2_f32_bf16 v68, v71, v15, v68
    v_dot2_f32_bf16 v72, v72, v12, 0
    v_dot2_f32_bf16 v76, v76, v12, 0
    v_dot2_f32_bf16 v80, v80, v12, 0
    v_dot2_f32_bf16 v84, v84, v12, 0
    v_dot2_f32_bf16 v72, v73, v13, v72
    v_dot2_f32_bf16 v76, v77, v13, v76
    v_dot2_f32_bf16 v80, v81, v13, v80
    v_dot2_f32_bf16 v84, v85, v13, v84
    v_dot2_f32_bf16 v72, v74, v14, v72
    v_dot2_f32_bf16 v76, v78, v14, v76
    v_dot2_f32_bf16 v80, v82, v14, v80
    v_dot2_f32_bf16 v84, v86, v14, v84
    v_dot2_f32_bf16 v72, v75, v15, v72
    v_dot2_f32_bf16 v76, v79, v15, v76
    v_dot2_f32_bf16 v80, v83, v15, v80
    v_dot2_f32_bf16 v84, v87, v15, v84
    v_add_f32_dpp v24, v24, v24 row_ror:8 row_mask:0xf bank_mask:0x3
    v_add_f32_dpp v28, v28, v28 row_ror:8 row_mask:0xf bank_mask:0x3
    v_add_f32_dpp v32, v32, v32 row_ror:8 row_mask:0xf bank_mask:0x3
    v_add_f32_dpp v36, v36, v36 row_ror:8 row_mask:0xf bank_mask:0x3
    v_add_f32_dpp v40, v40, v40 row_ror:8 row_mask:0xf bank_mask:0x3
    v_add_f32_dpp v44, v44, v44 row_ror:8 row_mask:0xf bank_mask:0x3
    v_add_f32_dpp v48, v48, v48 row_ror:8 row_mask:0xf bank_mask:0x3
    v_add_f32_dpp v52, v52, v52 row_ror:8 row_mask:0xf bank_mask:0x3
    v_add_f32_dpp v24, v56, v56 row_ror:8 row_mask:0xf bank_mask:0xc
    v_add_f32_dpp v28, v60, v60 row_ror:8 row_mask:0xf bank_mask:0xc
    v_add_f32_dpp v32, v64, v64 row_ror:8 row_mask:0xf bank_mask:0xc
    v_add_f32_dpp v36, v68, v68 row_ror:8 row_mask:0xf bank_mask:0xc
    v_add_f32_dpp v40, v72, v72 row_ror:8 row_mask:0xf bank_mask:0xc
    v_add_f32_dpp v44, v76, v76 row_ror:8 row_mask:0xf bank_mask:0xc
    v_add_f32_dpp v48, v80, v80 row_ror:8 row_mask:0xf bank_mask:0xc
    v_add_f32_dpp v52, v84, v84 row_ror:8 row_mask:0xf bank_mask:0xc
    v_add_f32_dpp v24, v24, v24 row_shl:4 row_mask:0xf bank_mask:0x5
    v_add_f32_dpp v28, v28, v28 row_shl:4 row_mask:0xf bank_mask:0x5
    v_add_f32_dpp v32, v32, v32 row_shl:4 row_mask:0xf bank_mask:0x5
    v_add_f32_dpp v36, v36, v36 row_shl:4 row_mask:0xf bank_mask:0x5
    v_add_f32_dpp v24, v40, v40 row_shr:4 row_mask:0xf bank_mask:0xa
    v_add_f32_dpp v28, v44, v44 row_shr:4 row_mask:0xf bank_mask:0xa
    v_add_f32_dpp v32, v48, v48 row_shr:4 row_mask:0xf bank_mask:0xa
    v_add_f32_dpp v36, v52, v52 row_shr:4 row_mask:0xf bank_mask:0xa
    v_add_f32_dpp v24, v24, v24 quad_perm:[2,3,0,1] row_mask:0xf bank_mask:0xf
    v_add_f32_dpp v28, v28, v28 quad_perm:[2,3,0,1] row_mask:0xf bank_mask:0xf
    v_add_f32_dpp v32, v32, v32 quad_perm:[2,3,0,1] row_mask:0xf bank_mask:0xf
    v_add_f32_dpp v36, v36, v36 quad_perm:[2,3,0,1] row_mask:0xf bank_mask:0xf
    v_cndmask_b32 v24, v24, v32, s[72:73]
    v_cndmask_b32 v28, v28, v36, s[72:73]
    s_nop 0
    v_add_f32_dpp v24, v24, v24 quad_perm:[1,0,3,2] row_mask:0xf bank_mask:0xf
    v_add_f32_dpp v28, v28, v28 quad_perm:[1,0,3,2] row_mask:0xf bank_mask:0xf
    v_cndmask_b32 v6, v24, v28, s[74:75]
    s_waitcnt vmcnt(3)
    s_mov_b32 s11, 0xc000
    buffer_load_dwordx4 v[24:27], v2, s[56:59], s11 offen nt
    v_dot2_f32_bf16 v88, v88, v12, 0
    v_dot2_f32_bf16 v92, v92, v12, 0
    v_dot2_f32_bf16 v96, v96, v12, 0
    v_dot2_f32_bf16 v100, v100, v12, 0
    v_dot2_f32_bf16 v88, v89, v13, v88
    v_dot2_f32_bf16 v92, v93, v13, v92
    v_dot2_f32_bf16 v96, v97, v13, v96
    v_dot2_f32_bf16 v100, v101, v13, v100
    v_dot2_f32_bf16 v88, v90, v14, v88
    v_dot2_f32_bf16 v92, v94, v14, v92
    v_dot2_f32_bf16 v96, v98, v14, v96
    v_dot2_f32_bf16 v100, v102, v14, v100
    v_dot2_f32_bf16 v88, v91, v15, v88
    v_dot2_f32_bf16 v92, v95, v15, v92
    v_dot2_f32_bf16 v96, v99, v15, v96
    v_dot2_f32_bf16 v100, v103, v15, v100
    v_dot2_f32_bf16 v104, v104, v12, 0
    v_dot2_f32_bf16 v108, v108, v12, 0
    v_dot2_f32_bf16 v112, v112, v12, 0
    v_dot2_f32_bf16 v116, v116, v12, 0
    v_dot2_f32_bf16 v104, v105, v13, v104
    v_dot2_f32_bf16 v108, v109, v13, v108
    v_dot2_f32_bf16 v112, v113, v13, v112
    v_dot2_f32_bf16 v116, v117, v13, v116
    v_dot2_f32_bf16 v104, v106, v14, v104
    v_dot2_f32_bf16 v108, v110, v14, v108
    v_dot2_f32_bf16 v112, v114, v14, v112
    v_dot2_f32_bf16 v116, v118, v14, v116
    v_dot2_f32_bf16 v104, v107, v15, v104
    v_dot2_f32_bf16 v108, v111, v15, v108
    v_dot2_f32_bf16 v112, v115, v15, v112
    v_dot2_f32_bf16 v116, v119, v15, v116
    v_dot2_f32_bf16 v120, v120, v12, 0
    v_dot2_f32_bf16 v124, v124, v12, 0
    v_dot2_f32_bf16 v128, v128, v12, 0
    v_dot2_f32_bf16 v132, v132, v12, 0
    v_dot2_f32_bf16 v120, v121, v13, v120
    v_dot2_f32_bf16 v124, v125, v13, v124
    v_dot2_f32_bf16 v128, v129, v13, v128
    v_dot2_f32_bf16 v132, v133, v13, v132
    v_dot2_f32_bf16 v120, v122, v14, v120
    v_dot2_f32_bf16 v124, v126, v14, v124
    v_dot2_f32_bf16 v128, v130, v14, v128
    v_dot2_f32_bf16 v132, v134, v14, v132
    v_dot2_f32_bf16 v120, v123, v15, v120
    v_dot2_f32_bf16 v124, v127, v15, v124
    v_dot2_f32_bf16 v128, v131, v15, v128
    v_dot2_f32_bf16 v132, v135, v15, v132
    v_dot2_f32_bf16 v136, v136, v12, 0
    v_dot2_f32_bf16 v140, v140, v12, 0
    v_dot2_f32_bf16 v136, v137, v13, v136
    v_dot2_f32_bf16 v140, v141, v13, v140
    v_dot2_f32_bf16 v136, v138, v14, v136
    v_dot2_f32_bf16 v140, v142, v14, v140
    v_dot2_f32_bf16 v136, v139, v15, v136
    v_dot2_f32_bf16 v140, v143, v15, v140
    v_add_f32_dpp v88, v88, v88 row_ror:8 row_mask:0xf bank_mask:0x3
    v_add_f32_dpp v92, v92, v92 row_ror:8 row_mask:0xf bank_mask:0x3
    v_add_f32_dpp v96, v96, v96 row_ror:8 row_mask:0xf bank_mask:0x3
    v_add_f32_dpp v100, v100, v100 row_ror:8 row_mask:0xf bank_mask:0x3
    v_add_f32_dpp v104, v104, v104 row_ror:8 row_mask:0xf bank_mask:0x3
    v_add_f32_dpp v108, v108, v108 row_ror:8 row_mask:0xf bank_mask:0x3
    v_add_f32_dpp v112, v112, v112 row_ror:8 row_mask:0xf bank_mask:0x3
    v_add_f32_dpp v116, v116, v116 row_ror:8 row_mask:0xf bank_mask:0x3
    v_add_f32_dpp v88, v120, v120 row_ror:8 row_mask:0xf bank_mask:0xc
    v_add_f32_dpp v92, v124, v124 row_ror:8 row_mask:0xf bank_mask:0xc
    v_add_f32_dpp v96, v128, v128 row_ror:8 row_mask:0xf bank_mask:0xc
    v_add_f32_dpp v100, v132, v132 row_ror:8 row_mask:0xf bank_mask:0xc
    v_add_f32_dpp v104, v136, v136 row_ror:8 row_mask:0xf bank_mask:0xc
    v_add_f32_dpp v108, v140, v140 row_ror:8 row_mask:0xf bank_mask:0xc
    v_add_f32_dpp v88, v88, v88 row_shl:4 row_mask:0xf bank_mask:0x5
    v_add_f32_dpp v92, v92, v92 row_shl:4 row_mask:0xf bank_mask:0x5
    v_add_f32_dpp v96, v96, v96 row_shl:4 row_mask:0xf bank_mask:0x5
    v_add_f32_dpp v100, v100, v100 row_shl:4 row_mask:0xf bank_mask:0x5
    v_add_f32_dpp v88, v104, v104 row_shr:4 row_mask:0xf bank_mask:0xa
    v_add_f32_dpp v92, v108, v108 row_shr:4 row_mask:0xf bank_mask:0xa
    v_add_f32_dpp v96, v112, v112 row_shr:4 row_mask:0xf bank_mask:0xa
    v_add_f32_dpp v100, v116, v116 row_shr:4 row_mask:0xf bank_mask:0xa
    v_add_f32_dpp v88, v88, v88 quad_perm:[2,3,0,1] row_mask:0xf bank_mask:0xf
    v_add_f32_dpp v92, v92, v92 quad_perm:[2,3,0,1] row_mask:0xf bank_mask:0xf
    v_add_f32_dpp v96, v96, v96 quad_perm:[2,3,0,1] row_mask:0xf bank_mask:0xf
    v_add_f32_dpp v100, v100, v100 quad_perm:[2,3,0,1] row_mask:0xf bank_mask:0xf
    v_cndmask_b32 v88, v88, v96, s[72:73]
    v_cndmask_b32 v92, v92, v100, s[72:73]
    s_nop 0
    v_add_f32_dpp v88, v88, v88 quad_perm:[1,0,3,2] row_mask:0xf bank_mask:0xf
    v_add_f32_dpp v92, v92, v92 quad_perm:[1,0,3,2] row_mask:0xf bank_mask:0xf
    v_mov_b32 v89, 0xff800000
    v_cndmask_b32 v88, v88, v92, s[74:75]
    v_cndmask_b32 v7, v89, v88, s[60:61]
    s_waitcnt vmcnt(3)
    s_mov_b32 s11, 0xe000
    buffer_load_dwordx4 v[28:31], v2, s[56:59], s11 offen nt
    v_cvt_pk_bf16_f32 v14, v6, v7
    v_lshlrev_b32 v6, 16, v14
    v_and_b32 v7, s78, v14
    v_mul_f32 v6, 0x3db504f3, v6
    v_mul_f32 v7, 0x3db504f3, v7
    v_cvt_pk_bf16_f32 v14, v6, v7
    v_lshlrev_b32 v6, 16, v14
    v_and_b32 v7, s78, v14
    v_max_f32 v12, v6, v7
    s_nop 1
    v_max_f32_dpp v12, v12, v12 row_ror:8 row_mask:0xf bank_mask:0xf
    s_nop 1
    v_max_f32_dpp v12, v12, v12 row_ror:4 row_mask:0xf bank_mask:0xf
    s_nop 1
    v_max_f32_dpp v12, v12, v12 row_ror:2 row_mask:0xf bank_mask:0xf
    s_nop 1
    v_max_f32_dpp v12, v12, v12 row_ror:1 row_mask:0xf bank_mask:0xf
    v_mov_b32 v14, v12
    s_nop 1
    v_permlane16_swap_b32 v12, v14
    v_max_f32 v12, v12, v14
    v_mov_b32 v14, v12
    s_nop 1
    v_permlane32_swap_b32 v12, v14
    v_max_f32 v12, v12, v14
    v_sub_f32 v6, v6, v12
    v_sub_f32 v7, v7, v12
    v_mul_f32 v6, 0x3fb8aa3b, v6
    v_mul_f32 v7, 0x3fb8aa3b, v7
    v_exp_f32 v6, v6
    v_exp_f32 v7, v7
    s_nop 0
    v_add_f32 v13, v6, v7
    v_cvt_pk_bf16_f32 v8, 0, v6
    v_cvt_pk_bf16_f32 v9, 0, v7
    v_cvt_pk_bf16_f32 v6, v6, 0
    v_cvt_pk_bf16_f32 v7, v7, 0
    v_add_f32_dpp v13, v13, v13 row_ror:8 row_mask:0xf bank_mask:0xf
    s_nop 1
    v_add_f32_dpp v13, v13, v13 row_ror:4 row_mask:0xf bank_mask:0xf
    s_nop 1
    v_add_f32_dpp v13, v13, v13 row_ror:2 row_mask:0xf bank_mask:0xf
    s_nop 1
    v_add_f32_dpp v13, v13, v13 row_ror:1 row_mask:0xf bank_mask:0xf
    v_mov_b32 v14, v13
    s_nop 1
    v_permlane16_swap_b32 v13, v14
    v_add_f32 v13, v13, v14
    v_mov_b32 v14, v13
    s_nop 1
    v_permlane32_swap_b32 v13, v14
    v_add_f32 v13, v13, v14
    v_mul_f32 v13, 0.25, v13
    s_and_b32 s14, s6, 3
    s_lshl_b32 s14, s14, 3
    s_lshr_b32 s12, 0xc6c5c7bd, s14
    s_and_b32 s12, s12, 0xff
    s_sub_u32 s69, 256, s12
    s_lshl_b32 s69, s69, 3
    s_lshl_b32 s12, s12, 13
    s_lshl_b32 s13, s6, 21
    s_add_u32 s47, s12, s13
    s_lshl_b32 s68, s6, 8
    s_add_u32 s68, s68, 0x54000
    s_waitcnt vmcnt(3)
    s_mov_b32 s11, 0x10000
    buffer_load_dwordx4 v[32:35], v2, s[56:59], s11 offen nt
    v_dot2c_f32_bf16_dpp v16, v6, v144 row_newbcast:0 row_mask:0xf bank_mask:0xf
    v_dot2c_f32_bf16_dpp v17, v8, v144 row_newbcast:0 row_mask:0xf bank_mask:0xf
    v_dot2c_f32_bf16_dpp v18, v6, v145 row_newbcast:0 row_mask:0xf bank_mask:0xf
    v_dot2c_f32_bf16_dpp v19, v8, v145 row_newbcast:0 row_mask:0xf bank_mask:0xf
    v_dot2c_f32_bf16_dpp v20, v6, v146 row_newbcast:0 row_mask:0xf bank_mask:0xf
    v_dot2c_f32_bf16_dpp v21, v8, v146 row_newbcast:0 row_mask:0xf bank_mask:0xf
    v_dot2c_f32_bf16_dpp v22, v6, v147 row_newbcast:0 row_mask:0xf bank_mask:0xf
    v_dot2c_f32_bf16_dpp v23, v8, v147 row_newbcast:0 row_mask:0xf bank_mask:0xf
    v_dot2c_f32_bf16_dpp v16, v6, v148 row_newbcast:1 row_mask:0xf bank_mask:0xf
    v_dot2c_f32_bf16_dpp v17, v8, v148 row_newbcast:1 row_mask:0xf bank_mask:0xf
    v_dot2c_f32_bf16_dpp v18, v6, v149 row_newbcast:1 row_mask:0xf bank_mask:0xf
    v_dot2c_f32_bf16_dpp v19, v8, v149 row_newbcast:1 row_mask:0xf bank_mask:0xf
    v_dot2c_f32_bf16_dpp v20, v6, v150 row_newbcast:1 row_mask:0xf bank_mask:0xf
    v_dot2c_f32_bf16_dpp v21, v8, v150 row_newbcast:1 row_mask:0xf bank_mask:0xf
    v_dot2c_f32_bf16_dpp v22, v6, v151 row_newbcast:1 row_mask:0xf bank_mask:0xf
    v_dot2c_f32_bf16_dpp v23, v8, v151 row_newbcast:1 row_mask:0xf bank_mask:0xf
    s_waitcnt vmcnt(3)
    s_mov_b32 s11, 0x12000
    buffer_load_dwordx4 v[36:39], v2, s[56:59], s11 offen nt
    v_dot2c_f32_bf16_dpp v16, v6, v152 row_newbcast:2 row_mask:0xf bank_mask:0xf
    v_dot2c_f32_bf16_dpp v17, v8, v152 row_newbcast:2 row_mask:0xf bank_mask:0xf
    v_dot2c_f32_bf16_dpp v18, v6, v153 row_newbcast:2 row_mask:0xf bank_mask:0xf
    v_dot2c_f32_bf16_dpp v19, v8, v153 row_newbcast:2 row_mask:0xf bank_mask:0xf
    v_dot2c_f32_bf16_dpp v20, v6, v154 row_newbcast:2 row_mask:0xf bank_mask:0xf
    v_dot2c_f32_bf16_dpp v21, v8, v154 row_newbcast:2 row_mask:0xf bank_mask:0xf
    v_dot2c_f32_bf16_dpp v22, v6, v155 row_newbcast:2 row_mask:0xf bank_mask:0xf
    v_dot2c_f32_bf16_dpp v23, v8, v155 row_newbcast:2 row_mask:0xf bank_mask:0xf
    v_dot2c_f32_bf16_dpp v16, v6, v156 row_newbcast:3 row_mask:0xf bank_mask:0xf
    v_dot2c_f32_bf16_dpp v17, v8, v156 row_newbcast:3 row_mask:0xf bank_mask:0xf
    v_dot2c_f32_bf16_dpp v18, v6, v157 row_newbcast:3 row_mask:0xf bank_mask:0xf
    v_dot2c_f32_bf16_dpp v19, v8, v157 row_newbcast:3 row_mask:0xf bank_mask:0xf
    v_dot2c_f32_bf16_dpp v20, v6, v158 row_newbcast:3 row_mask:0xf bank_mask:0xf
    v_dot2c_f32_bf16_dpp v21, v8, v158 row_newbcast:3 row_mask:0xf bank_mask:0xf
    v_dot2c_f32_bf16_dpp v22, v6, v159 row_newbcast:3 row_mask:0xf bank_mask:0xf
    v_dot2c_f32_bf16_dpp v23, v8, v159 row_newbcast:3 row_mask:0xf bank_mask:0xf
    s_waitcnt vmcnt(3)
    s_mov_b32 s11, 0x14000
    buffer_load_dwordx4 v[40:43], v2, s[56:59], s11 offen nt
    v_dot2c_f32_bf16_dpp v16, v6, v160 row_newbcast:4 row_mask:0xf bank_mask:0xf
    v_dot2c_f32_bf16_dpp v17, v8, v160 row_newbcast:4 row_mask:0xf bank_mask:0xf
    v_dot2c_f32_bf16_dpp v18, v6, v161 row_newbcast:4 row_mask:0xf bank_mask:0xf
    v_dot2c_f32_bf16_dpp v19, v8, v161 row_newbcast:4 row_mask:0xf bank_mask:0xf
    v_dot2c_f32_bf16_dpp v20, v6, v162 row_newbcast:4 row_mask:0xf bank_mask:0xf
    v_dot2c_f32_bf16_dpp v21, v8, v162 row_newbcast:4 row_mask:0xf bank_mask:0xf
    v_dot2c_f32_bf16_dpp v22, v6, v163 row_newbcast:4 row_mask:0xf bank_mask:0xf
    v_dot2c_f32_bf16_dpp v23, v8, v163 row_newbcast:4 row_mask:0xf bank_mask:0xf
    v_dot2c_f32_bf16_dpp v16, v6, v164 row_newbcast:5 row_mask:0xf bank_mask:0xf
    v_dot2c_f32_bf16_dpp v17, v8, v164 row_newbcast:5 row_mask:0xf bank_mask:0xf
    v_dot2c_f32_bf16_dpp v18, v6, v165 row_newbcast:5 row_mask:0xf bank_mask:0xf
    v_dot2c_f32_bf16_dpp v19, v8, v165 row_newbcast:5 row_mask:0xf bank_mask:0xf
    v_dot2c_f32_bf16_dpp v20, v6, v166 row_newbcast:5 row_mask:0xf bank_mask:0xf
    v_dot2c_f32_bf16_dpp v21, v8, v166 row_newbcast:5 row_mask:0xf bank_mask:0xf
    v_dot2c_f32_bf16_dpp v22, v6, v167 row_newbcast:5 row_mask:0xf bank_mask:0xf
    v_dot2c_f32_bf16_dpp v23, v8, v167 row_newbcast:5 row_mask:0xf bank_mask:0xf
    s_waitcnt vmcnt(3)
    s_mov_b32 s11, 0x16000
    buffer_load_dwordx4 v[44:47], v2, s[56:59], s11 offen nt
    v_dot2c_f32_bf16_dpp v16, v6, v24 row_newbcast:6 row_mask:0xf bank_mask:0xf
    v_dot2c_f32_bf16_dpp v17, v8, v24 row_newbcast:6 row_mask:0xf bank_mask:0xf
    v_dot2c_f32_bf16_dpp v18, v6, v25 row_newbcast:6 row_mask:0xf bank_mask:0xf
    v_dot2c_f32_bf16_dpp v19, v8, v25 row_newbcast:6 row_mask:0xf bank_mask:0xf
    v_dot2c_f32_bf16_dpp v20, v6, v26 row_newbcast:6 row_mask:0xf bank_mask:0xf
    v_dot2c_f32_bf16_dpp v21, v8, v26 row_newbcast:6 row_mask:0xf bank_mask:0xf
    v_dot2c_f32_bf16_dpp v22, v6, v27 row_newbcast:6 row_mask:0xf bank_mask:0xf
    v_dot2c_f32_bf16_dpp v23, v8, v27 row_newbcast:6 row_mask:0xf bank_mask:0xf
    v_dot2c_f32_bf16_dpp v16, v6, v28 row_newbcast:7 row_mask:0xf bank_mask:0xf
    v_dot2c_f32_bf16_dpp v17, v8, v28 row_newbcast:7 row_mask:0xf bank_mask:0xf
    v_dot2c_f32_bf16_dpp v18, v6, v29 row_newbcast:7 row_mask:0xf bank_mask:0xf
    v_dot2c_f32_bf16_dpp v19, v8, v29 row_newbcast:7 row_mask:0xf bank_mask:0xf
    v_dot2c_f32_bf16_dpp v20, v6, v30 row_newbcast:7 row_mask:0xf bank_mask:0xf
    v_dot2c_f32_bf16_dpp v21, v8, v30 row_newbcast:7 row_mask:0xf bank_mask:0xf
    v_dot2c_f32_bf16_dpp v22, v6, v31 row_newbcast:7 row_mask:0xf bank_mask:0xf
    v_dot2c_f32_bf16_dpp v23, v8, v31 row_newbcast:7 row_mask:0xf bank_mask:0xf
    s_waitcnt vmcnt(3)
    s_mov_b32 s11, 0x18000
    buffer_load_dwordx4 v[48:51], v2, s[56:59], s11 offen nt
    v_dot2c_f32_bf16_dpp v16, v6, v32 row_newbcast:8 row_mask:0xf bank_mask:0xf
    v_dot2c_f32_bf16_dpp v17, v8, v32 row_newbcast:8 row_mask:0xf bank_mask:0xf
    v_dot2c_f32_bf16_dpp v18, v6, v33 row_newbcast:8 row_mask:0xf bank_mask:0xf
    v_dot2c_f32_bf16_dpp v19, v8, v33 row_newbcast:8 row_mask:0xf bank_mask:0xf
    v_dot2c_f32_bf16_dpp v20, v6, v34 row_newbcast:8 row_mask:0xf bank_mask:0xf
    v_dot2c_f32_bf16_dpp v21, v8, v34 row_newbcast:8 row_mask:0xf bank_mask:0xf
    v_dot2c_f32_bf16_dpp v22, v6, v35 row_newbcast:8 row_mask:0xf bank_mask:0xf
    v_dot2c_f32_bf16_dpp v23, v8, v35 row_newbcast:8 row_mask:0xf bank_mask:0xf
    s_waitcnt vmcnt(3)
    s_mov_b32 s11, 0x1a000
    buffer_load_dwordx4 v[52:55], v2, s[56:59], s11 offen nt
    v_dot2c_f32_bf16_dpp v16, v6, v36 row_newbcast:9 row_mask:0xf bank_mask:0xf
    v_dot2c_f32_bf16_dpp v17, v8, v36 row_newbcast:9 row_mask:0xf bank_mask:0xf
    v_dot2c_f32_bf16_dpp v18, v6, v37 row_newbcast:9 row_mask:0xf bank_mask:0xf
    v_dot2c_f32_bf16_dpp v19, v8, v37 row_newbcast:9 row_mask:0xf bank_mask:0xf
    v_dot2c_f32_bf16_dpp v20, v6, v38 row_newbcast:9 row_mask:0xf bank_mask:0xf
    v_dot2c_f32_bf16_dpp v21, v8, v38 row_newbcast:9 row_mask:0xf bank_mask:0xf
    v_dot2c_f32_bf16_dpp v22, v6, v39 row_newbcast:9 row_mask:0xf bank_mask:0xf
    v_dot2c_f32_bf16_dpp v23, v8, v39 row_newbcast:9 row_mask:0xf bank_mask:0xf
    s_waitcnt vmcnt(3)
    s_mov_b32 s11, 0x1c000
    buffer_load_dwordx4 v[56:59], v2, s[56:59], s11 offen nt
    v_dot2c_f32_bf16_dpp v16, v6, v40 row_newbcast:10 row_mask:0xf bank_mask:0xf
    v_dot2c_f32_bf16_dpp v17, v8, v40 row_newbcast:10 row_mask:0xf bank_mask:0xf
    v_dot2c_f32_bf16_dpp v18, v6, v41 row_newbcast:10 row_mask:0xf bank_mask:0xf
    v_dot2c_f32_bf16_dpp v19, v8, v41 row_newbcast:10 row_mask:0xf bank_mask:0xf
    v_dot2c_f32_bf16_dpp v20, v6, v42 row_newbcast:10 row_mask:0xf bank_mask:0xf
    v_dot2c_f32_bf16_dpp v21, v8, v42 row_newbcast:10 row_mask:0xf bank_mask:0xf
    v_dot2c_f32_bf16_dpp v22, v6, v43 row_newbcast:10 row_mask:0xf bank_mask:0xf
    v_dot2c_f32_bf16_dpp v23, v8, v43 row_newbcast:10 row_mask:0xf bank_mask:0xf
    s_waitcnt vmcnt(3)
    s_mov_b32 s11, 0x1e000
    buffer_load_dwordx4 v[60:63], v2, s[56:59], s11 offen nt
    v_dot2c_f32_bf16_dpp v16, v6, v44 row_newbcast:11 row_mask:0xf bank_mask:0xf
    v_dot2c_f32_bf16_dpp v17, v8, v44 row_newbcast:11 row_mask:0xf bank_mask:0xf
    v_dot2c_f32_bf16_dpp v18, v6, v45 row_newbcast:11 row_mask:0xf bank_mask:0xf
    v_dot2c_f32_bf16_dpp v19, v8, v45 row_newbcast:11 row_mask:0xf bank_mask:0xf
    v_dot2c_f32_bf16_dpp v20, v6, v46 row_newbcast:11 row_mask:0xf bank_mask:0xf
    v_dot2c_f32_bf16_dpp v21, v8, v46 row_newbcast:11 row_mask:0xf bank_mask:0xf
    v_dot2c_f32_bf16_dpp v22, v6, v47 row_newbcast:11 row_mask:0xf bank_mask:0xf
    v_dot2c_f32_bf16_dpp v23, v8, v47 row_newbcast:11 row_mask:0xf bank_mask:0xf
    s_waitcnt vmcnt(3)
    s_mov_b32 s11, 0x20000
    buffer_load_dwordx4 v[64:67], v2, s[56:59], s11 offen nt
    v_dot2c_f32_bf16_dpp v16, v6, v48 row_newbcast:12 row_mask:0xf bank_mask:0xf
    v_dot2c_f32_bf16_dpp v17, v8, v48 row_newbcast:12 row_mask:0xf bank_mask:0xf
    v_dot2c_f32_bf16_dpp v18, v6, v49 row_newbcast:12 row_mask:0xf bank_mask:0xf
    v_dot2c_f32_bf16_dpp v19, v8, v49 row_newbcast:12 row_mask:0xf bank_mask:0xf
    v_dot2c_f32_bf16_dpp v20, v6, v50 row_newbcast:12 row_mask:0xf bank_mask:0xf
    v_dot2c_f32_bf16_dpp v21, v8, v50 row_newbcast:12 row_mask:0xf bank_mask:0xf
    v_dot2c_f32_bf16_dpp v22, v6, v51 row_newbcast:12 row_mask:0xf bank_mask:0xf
    v_dot2c_f32_bf16_dpp v23, v8, v51 row_newbcast:12 row_mask:0xf bank_mask:0xf
    s_waitcnt vmcnt(3)
    s_mov_b32 s11, 0x22000
    buffer_load_dwordx4 v[68:71], v2, s[56:59], s11 offen nt
    v_dot2c_f32_bf16_dpp v16, v6, v52 row_newbcast:13 row_mask:0xf bank_mask:0xf
    v_dot2c_f32_bf16_dpp v17, v8, v52 row_newbcast:13 row_mask:0xf bank_mask:0xf
    v_dot2c_f32_bf16_dpp v18, v6, v53 row_newbcast:13 row_mask:0xf bank_mask:0xf
    v_dot2c_f32_bf16_dpp v19, v8, v53 row_newbcast:13 row_mask:0xf bank_mask:0xf
    v_dot2c_f32_bf16_dpp v20, v6, v54 row_newbcast:13 row_mask:0xf bank_mask:0xf
    v_dot2c_f32_bf16_dpp v21, v8, v54 row_newbcast:13 row_mask:0xf bank_mask:0xf
    v_dot2c_f32_bf16_dpp v22, v6, v55 row_newbcast:13 row_mask:0xf bank_mask:0xf
    v_dot2c_f32_bf16_dpp v23, v8, v55 row_newbcast:13 row_mask:0xf bank_mask:0xf
    s_waitcnt vmcnt(3)
    s_mov_b32 s11, 0x24000
    buffer_load_dwordx4 v[72:75], v2, s[56:59], s11 offen nt
    v_dot2c_f32_bf16_dpp v16, v6, v56 row_newbcast:14 row_mask:0xf bank_mask:0xf
    v_dot2c_f32_bf16_dpp v17, v8, v56 row_newbcast:14 row_mask:0xf bank_mask:0xf
    v_dot2c_f32_bf16_dpp v18, v6, v57 row_newbcast:14 row_mask:0xf bank_mask:0xf
    v_dot2c_f32_bf16_dpp v19, v8, v57 row_newbcast:14 row_mask:0xf bank_mask:0xf
    v_dot2c_f32_bf16_dpp v20, v6, v58 row_newbcast:14 row_mask:0xf bank_mask:0xf
    v_dot2c_f32_bf16_dpp v21, v8, v58 row_newbcast:14 row_mask:0xf bank_mask:0xf
    v_dot2c_f32_bf16_dpp v22, v6, v59 row_newbcast:14 row_mask:0xf bank_mask:0xf
    v_dot2c_f32_bf16_dpp v23, v8, v59 row_newbcast:14 row_mask:0xf bank_mask:0xf
    s_waitcnt vmcnt(3)
    s_mov_b32 s11, 0x26000
    buffer_load_dwordx4 v[76:79], v2, s[56:59], s11 offen nt
    v_dot2c_f32_bf16_dpp v16, v6, v60 row_newbcast:15 row_mask:0xf bank_mask:0xf
    v_dot2c_f32_bf16_dpp v17, v8, v60 row_newbcast:15 row_mask:0xf bank_mask:0xf
    v_dot2c_f32_bf16_dpp v18, v6, v61 row_newbcast:15 row_mask:0xf bank_mask:0xf
    v_dot2c_f32_bf16_dpp v19, v8, v61 row_newbcast:15 row_mask:0xf bank_mask:0xf
    v_dot2c_f32_bf16_dpp v20, v6, v62 row_newbcast:15 row_mask:0xf bank_mask:0xf
    v_dot2c_f32_bf16_dpp v21, v8, v62 row_newbcast:15 row_mask:0xf bank_mask:0xf
    v_dot2c_f32_bf16_dpp v22, v6, v63 row_newbcast:15 row_mask:0xf bank_mask:0xf
    v_dot2c_f32_bf16_dpp v23, v8, v63 row_newbcast:15 row_mask:0xf bank_mask:0xf
    s_waitcnt vmcnt(3)
    s_mov_b32 s11, 0x28000
    buffer_load_dwordx4 v[80:83], v2, s[56:59], s11 offen nt
    v_dot2c_f32_bf16_dpp v16, v7, v64 row_newbcast:0 row_mask:0xf bank_mask:0xf
    v_dot2c_f32_bf16_dpp v17, v9, v64 row_newbcast:0 row_mask:0xf bank_mask:0xf
    v_dot2c_f32_bf16_dpp v18, v7, v65 row_newbcast:0 row_mask:0xf bank_mask:0xf
    v_dot2c_f32_bf16_dpp v19, v9, v65 row_newbcast:0 row_mask:0xf bank_mask:0xf
    v_dot2c_f32_bf16_dpp v20, v7, v66 row_newbcast:0 row_mask:0xf bank_mask:0xf
    v_dot2c_f32_bf16_dpp v21, v9, v66 row_newbcast:0 row_mask:0xf bank_mask:0xf
    v_dot2c_f32_bf16_dpp v22, v7, v67 row_newbcast:0 row_mask:0xf bank_mask:0xf
    v_dot2c_f32_bf16_dpp v23, v9, v67 row_newbcast:0 row_mask:0xf bank_mask:0xf
    s_waitcnt vmcnt(3)
    s_mov_b32 s11, 0x2a000
    buffer_load_dwordx4 v[84:87], v2, s[56:59], s11 offen nt
    v_dot2c_f32_bf16_dpp v16, v7, v68 row_newbcast:1 row_mask:0xf bank_mask:0xf
    v_dot2c_f32_bf16_dpp v17, v9, v68 row_newbcast:1 row_mask:0xf bank_mask:0xf
    v_dot2c_f32_bf16_dpp v18, v7, v69 row_newbcast:1 row_mask:0xf bank_mask:0xf
    v_dot2c_f32_bf16_dpp v19, v9, v69 row_newbcast:1 row_mask:0xf bank_mask:0xf
    v_dot2c_f32_bf16_dpp v20, v7, v70 row_newbcast:1 row_mask:0xf bank_mask:0xf
    v_dot2c_f32_bf16_dpp v21, v9, v70 row_newbcast:1 row_mask:0xf bank_mask:0xf
    v_dot2c_f32_bf16_dpp v22, v7, v71 row_newbcast:1 row_mask:0xf bank_mask:0xf
    v_dot2c_f32_bf16_dpp v23, v9, v71 row_newbcast:1 row_mask:0xf bank_mask:0xf
    s_waitcnt vmcnt(3)
    s_mov_b32 s11, 0x2c000
    buffer_load_dwordx4 v[88:91], v2, s[56:59], s11 offen nt
    v_dot2c_f32_bf16_dpp v16, v7, v72 row_newbcast:2 row_mask:0xf bank_mask:0xf
    v_dot2c_f32_bf16_dpp v17, v9, v72 row_newbcast:2 row_mask:0xf bank_mask:0xf
    v_dot2c_f32_bf16_dpp v18, v7, v73 row_newbcast:2 row_mask:0xf bank_mask:0xf
    v_dot2c_f32_bf16_dpp v19, v9, v73 row_newbcast:2 row_mask:0xf bank_mask:0xf
    v_dot2c_f32_bf16_dpp v20, v7, v74 row_newbcast:2 row_mask:0xf bank_mask:0xf
    v_dot2c_f32_bf16_dpp v21, v9, v74 row_newbcast:2 row_mask:0xf bank_mask:0xf
    v_dot2c_f32_bf16_dpp v22, v7, v75 row_newbcast:2 row_mask:0xf bank_mask:0xf
    v_dot2c_f32_bf16_dpp v23, v9, v75 row_newbcast:2 row_mask:0xf bank_mask:0xf
    s_waitcnt vmcnt(3)
    s_mov_b32 s11, 0x2e000
    buffer_load_dwordx4 v[92:95], v2, s[56:59], s11 offen nt
    v_dot2c_f32_bf16_dpp v16, v7, v76 row_newbcast:3 row_mask:0xf bank_mask:0xf
    v_dot2c_f32_bf16_dpp v17, v9, v76 row_newbcast:3 row_mask:0xf bank_mask:0xf
    v_dot2c_f32_bf16_dpp v18, v7, v77 row_newbcast:3 row_mask:0xf bank_mask:0xf
    v_dot2c_f32_bf16_dpp v19, v9, v77 row_newbcast:3 row_mask:0xf bank_mask:0xf
    v_dot2c_f32_bf16_dpp v20, v7, v78 row_newbcast:3 row_mask:0xf bank_mask:0xf
    v_dot2c_f32_bf16_dpp v21, v9, v78 row_newbcast:3 row_mask:0xf bank_mask:0xf
    v_dot2c_f32_bf16_dpp v22, v7, v79 row_newbcast:3 row_mask:0xf bank_mask:0xf
    v_dot2c_f32_bf16_dpp v23, v9, v79 row_newbcast:3 row_mask:0xf bank_mask:0xf
    s_waitcnt vmcnt(3)
    s_mov_b32 s11, 0x30000
    buffer_load_dwordx4 v[96:99], v2, s[56:59], s11 offen nt
    v_dot2c_f32_bf16_dpp v16, v7, v80 row_newbcast:4 row_mask:0xf bank_mask:0xf
    v_dot2c_f32_bf16_dpp v17, v9, v80 row_newbcast:4 row_mask:0xf bank_mask:0xf
    v_dot2c_f32_bf16_dpp v18, v7, v81 row_newbcast:4 row_mask:0xf bank_mask:0xf
    v_dot2c_f32_bf16_dpp v19, v9, v81 row_newbcast:4 row_mask:0xf bank_mask:0xf
    v_dot2c_f32_bf16_dpp v20, v7, v82 row_newbcast:4 row_mask:0xf bank_mask:0xf
    v_dot2c_f32_bf16_dpp v21, v9, v82 row_newbcast:4 row_mask:0xf bank_mask:0xf
    v_dot2c_f32_bf16_dpp v22, v7, v83 row_newbcast:4 row_mask:0xf bank_mask:0xf
    v_dot2c_f32_bf16_dpp v23, v9, v83 row_newbcast:4 row_mask:0xf bank_mask:0xf
    s_waitcnt vmcnt(3)
    s_mov_b32 s11, 0x32000
    buffer_load_dwordx4 v[100:103], v2, s[56:59], s11 offen nt
    v_dot2c_f32_bf16_dpp v16, v7, v84 row_newbcast:5 row_mask:0xf bank_mask:0xf
    v_dot2c_f32_bf16_dpp v17, v9, v84 row_newbcast:5 row_mask:0xf bank_mask:0xf
    v_dot2c_f32_bf16_dpp v18, v7, v85 row_newbcast:5 row_mask:0xf bank_mask:0xf
    v_dot2c_f32_bf16_dpp v19, v9, v85 row_newbcast:5 row_mask:0xf bank_mask:0xf
    v_dot2c_f32_bf16_dpp v20, v7, v86 row_newbcast:5 row_mask:0xf bank_mask:0xf
    v_dot2c_f32_bf16_dpp v21, v9, v86 row_newbcast:5 row_mask:0xf bank_mask:0xf
    v_dot2c_f32_bf16_dpp v22, v7, v87 row_newbcast:5 row_mask:0xf bank_mask:0xf
    v_dot2c_f32_bf16_dpp v23, v9, v87 row_newbcast:5 row_mask:0xf bank_mask:0xf
    s_waitcnt vmcnt(3)
    s_mov_b32 s11, 0x34000
    buffer_load_dwordx4 v[104:107], v2, s[56:59], s11 offen nt
    v_dot2c_f32_bf16_dpp v16, v7, v88 row_newbcast:6 row_mask:0xf bank_mask:0xf
    v_dot2c_f32_bf16_dpp v17, v9, v88 row_newbcast:6 row_mask:0xf bank_mask:0xf
    v_dot2c_f32_bf16_dpp v18, v7, v89 row_newbcast:6 row_mask:0xf bank_mask:0xf
    v_dot2c_f32_bf16_dpp v19, v9, v89 row_newbcast:6 row_mask:0xf bank_mask:0xf
    v_dot2c_f32_bf16_dpp v20, v7, v90 row_newbcast:6 row_mask:0xf bank_mask:0xf
    v_dot2c_f32_bf16_dpp v21, v9, v90 row_newbcast:6 row_mask:0xf bank_mask:0xf
    v_dot2c_f32_bf16_dpp v22, v7, v91 row_newbcast:6 row_mask:0xf bank_mask:0xf
    v_dot2c_f32_bf16_dpp v23, v9, v91 row_newbcast:6 row_mask:0xf bank_mask:0xf
    s_waitcnt vmcnt(3)
    s_mov_b32 s11, 0x36000
    buffer_load_dwordx4 v[108:111], v2, s[56:59], s11 offen nt
    v_dot2c_f32_bf16_dpp v16, v7, v92 row_newbcast:7 row_mask:0xf bank_mask:0xf
    v_dot2c_f32_bf16_dpp v17, v9, v92 row_newbcast:7 row_mask:0xf bank_mask:0xf
    v_dot2c_f32_bf16_dpp v18, v7, v93 row_newbcast:7 row_mask:0xf bank_mask:0xf
    v_dot2c_f32_bf16_dpp v19, v9, v93 row_newbcast:7 row_mask:0xf bank_mask:0xf
    v_dot2c_f32_bf16_dpp v20, v7, v94 row_newbcast:7 row_mask:0xf bank_mask:0xf
    v_dot2c_f32_bf16_dpp v21, v9, v94 row_newbcast:7 row_mask:0xf bank_mask:0xf
    v_dot2c_f32_bf16_dpp v22, v7, v95 row_newbcast:7 row_mask:0xf bank_mask:0xf
    v_dot2c_f32_bf16_dpp v23, v9, v95 row_newbcast:7 row_mask:0xf bank_mask:0xf
    s_waitcnt vmcnt(3)
    s_mov_b32 s11, 0x38000
    buffer_load_dwordx4 v[112:115], v2, s[56:59], s11 offen nt
    v_dot2c_f32_bf16_dpp v16, v7, v96 row_newbcast:8 row_mask:0xf bank_mask:0xf
    v_dot2c_f32_bf16_dpp v17, v9, v96 row_newbcast:8 row_mask:0xf bank_mask:0xf
    v_dot2c_f32_bf16_dpp v18, v7, v97 row_newbcast:8 row_mask:0xf bank_mask:0xf
    v_dot2c_f32_bf16_dpp v19, v9, v97 row_newbcast:8 row_mask:0xf bank_mask:0xf
    v_dot2c_f32_bf16_dpp v20, v7, v98 row_newbcast:8 row_mask:0xf bank_mask:0xf
    v_dot2c_f32_bf16_dpp v21, v9, v98 row_newbcast:8 row_mask:0xf bank_mask:0xf
    v_dot2c_f32_bf16_dpp v22, v7, v99 row_newbcast:8 row_mask:0xf bank_mask:0xf
    v_dot2c_f32_bf16_dpp v23, v9, v99 row_newbcast:8 row_mask:0xf bank_mask:0xf
    v_mov_b32 v0, 2
    s_mov_b64 exec, 1
    buffer_atomic_add v0, v10, s[48:51], s68 offen sc0 sc1
    s_mov_b64 exec, -1
    s_waitcnt vmcnt(3)
    s_mov_b32 s11, 0x3a000
    buffer_load_dwordx4 v[116:119], v2, s[56:59], s11 offen nt
    v_dot2c_f32_bf16_dpp v16, v7, v100 row_newbcast:9 row_mask:0xf bank_mask:0xf
    v_dot2c_f32_bf16_dpp v17, v9, v100 row_newbcast:9 row_mask:0xf bank_mask:0xf
    v_dot2c_f32_bf16_dpp v18, v7, v101 row_newbcast:9 row_mask:0xf bank_mask:0xf
    v_dot2c_f32_bf16_dpp v19, v9, v101 row_newbcast:9 row_mask:0xf bank_mask:0xf
    v_dot2c_f32_bf16_dpp v20, v7, v102 row_newbcast:9 row_mask:0xf bank_mask:0xf
    v_dot2c_f32_bf16_dpp v21, v9, v102 row_newbcast:9 row_mask:0xf bank_mask:0xf
    v_dot2c_f32_bf16_dpp v22, v7, v103 row_newbcast:9 row_mask:0xf bank_mask:0xf
    v_dot2c_f32_bf16_dpp v23, v9, v103 row_newbcast:9 row_mask:0xf bank_mask:0xf
    v_dot2c_f32_bf16_dpp v16, v7, v104 row_newbcast:10 row_mask:0xf bank_mask:0xf
    v_dot2c_f32_bf16_dpp v17, v9, v104 row_newbcast:10 row_mask:0xf bank_mask:0xf
    v_dot2c_f32_bf16_dpp v18, v7, v105 row_newbcast:10 row_mask:0xf bank_mask:0xf
    v_dot2c_f32_bf16_dpp v19, v9, v105 row_newbcast:10 row_mask:0xf bank_mask:0xf
    v_dot2c_f32_bf16_dpp v20, v7, v106 row_newbcast:10 row_mask:0xf bank_mask:0xf
    v_dot2c_f32_bf16_dpp v21, v9, v106 row_newbcast:10 row_mask:0xf bank_mask:0xf
    v_dot2c_f32_bf16_dpp v22, v7, v107 row_newbcast:10 row_mask:0xf bank_mask:0xf
    v_dot2c_f32_bf16_dpp v23, v9, v107 row_newbcast:10 row_mask:0xf bank_mask:0xf
    s_cmp_lg_u32 s3, 0
    s_nop 0
    s_cbranch_scc1 L_tg_3
    ds_write_b32 v10, v11 offset:4
L_tg_3:
    s_add_u32 s52, s18, s47
    s_addc_u32 s53, s19, 0
    s_lshl_b32 s54, s69, 10
    s_add_u32 s56, s20, s47
    s_addc_u32 s57, s21, 0
    s_mov_b32 s58, s54
    s_waitcnt vmcnt(1)
    v_readfirstlane_b32 s70, v0
    s_nop 0
    s_min_u32 s70, s70, s69
    s_lshl_b32 s11, s70, 10
    buffer_load_dwordx4 v[120:123], v4, s[52:55], s11 offen offset:0 nt
    buffer_load_dwordx4 v[124:127], v4, s[52:55], s11 offen offset:1024 nt
    buffer_load_dwordx4 v[128:131], v4, s[56:59], s11 offen offset:0 nt
    buffer_load_dwordx4 v[132:135], v4, s[56:59], s11 offen offset:1024 nt
    v_mov_b32 v0, 2
    s_mov_b64 exec, 1
    buffer_atomic_add v0, v10, s[48:51], s68 offen sc0 sc1
    s_mov_b64 exec, -1
    v_dot2c_f32_bf16_dpp v16, v7, v108 row_newbcast:11 row_mask:0xf bank_mask:0xf
    v_dot2c_f32_bf16_dpp v17, v9, v108 row_newbcast:11 row_mask:0xf bank_mask:0xf
    v_dot2c_f32_bf16_dpp v18, v7, v109 row_newbcast:11 row_mask:0xf bank_mask:0xf
    v_dot2c_f32_bf16_dpp v19, v9, v109 row_newbcast:11 row_mask:0xf bank_mask:0xf
    v_dot2c_f32_bf16_dpp v20, v7, v110 row_newbcast:11 row_mask:0xf bank_mask:0xf
    v_dot2c_f32_bf16_dpp v21, v9, v110 row_newbcast:11 row_mask:0xf bank_mask:0xf
    v_dot2c_f32_bf16_dpp v22, v7, v111 row_newbcast:11 row_mask:0xf bank_mask:0xf
    v_dot2c_f32_bf16_dpp v23, v9, v111 row_newbcast:11 row_mask:0xf bank_mask:0xf
    v_dot2c_f32_bf16_dpp v16, v7, v112 row_newbcast:12 row_mask:0xf bank_mask:0xf
    v_dot2c_f32_bf16_dpp v17, v9, v112 row_newbcast:12 row_mask:0xf bank_mask:0xf
    v_dot2c_f32_bf16_dpp v18, v7, v113 row_newbcast:12 row_mask:0xf bank_mask:0xf
    v_dot2c_f32_bf16_dpp v19, v9, v113 row_newbcast:12 row_mask:0xf bank_mask:0xf
    v_dot2c_f32_bf16_dpp v20, v7, v114 row_newbcast:12 row_mask:0xf bank_mask:0xf
    v_dot2c_f32_bf16_dpp v21, v9, v114 row_newbcast:12 row_mask:0xf bank_mask:0xf
    v_dot2c_f32_bf16_dpp v22, v7, v115 row_newbcast:12 row_mask:0xf bank_mask:0xf
    v_dot2c_f32_bf16_dpp v23, v9, v115 row_newbcast:12 row_mask:0xf bank_mask:0xf
    s_waitcnt vmcnt(5)
    v_dot2c_f32_bf16_dpp v16, v7, v116 row_newbcast:13 row_mask:0xf bank_mask:0xf
    v_dot2c_f32_bf16_dpp v17, v9, v116 row_newbcast:13 row_mask:0xf bank_mask:0xf
    v_dot2c_f32_bf16_dpp v18, v7, v117 row_newbcast:13 row_mask:0xf bank_mask:0xf
    v_dot2c_f32_bf16_dpp v19, v9, v117 row_newbcast:13 row_mask:0xf bank_mask:0xf
    v_dot2c_f32_bf16_dpp v20, v7, v118 row_newbcast:13 row_mask:0xf bank_mask:0xf
    v_dot2c_f32_bf16_dpp v21, v9, v118 row_newbcast:13 row_mask:0xf bank_mask:0xf
    v_dot2c_f32_bf16_dpp v22, v7, v119 row_newbcast:13 row_mask:0xf bank_mask:0xf
    v_dot2c_f32_bf16_dpp v23, v9, v119 row_newbcast:13 row_mask:0xf bank_mask:0xf
    v_and_b32 v14, 15, v1
    v_lshlrev_b32 v14, 4, v14
    ds_read_b128 v[152:155], v14 offset:64
    s_waitcnt lgkmcnt(0)
    s_nop 0
L_dyn_4:
    s_cmp_ge_u32 s70, s69
    s_cbranch_scc1 L_dynd_5
    s_waitcnt vmcnt(0)
    v_readfirstlane_b32 s71, v0
    s_nop 0
    s_cmp_ge_u32 s71, s69
    s_nop 1
    s_cbranch_scc1 L_dyns_6
    s_lshl_b32 s11, s71, 10
    buffer_load_dwordx4 v[136:139], v4, s[52:55], s11 offen offset:0 nt
    buffer_load_dwordx4 v[140:143], v4, s[52:55], s11 offen offset:1024 nt
    buffer_load_dwordx4 v[144:147], v4, s[56:59], s11 offen offset:0 nt
    buffer_load_dwordx4 v[148:151], v4, s[56:59], s11 offen offset:1024 nt
    v_mov_b32 v0, 2
    s_mov_b64 exec, 1
    buffer_atomic_add v0, v10, s[48:51], s68 offen sc0 sc1
    s_mov_b64 exec, -1
L_dyns_6:
    v_dot2_f32_bf16 v120, v120, v152, 0
    v_dot2_f32_bf16 v124, v124, v152, 0
    v_dot2_f32_bf16 v120, v121, v153, v120
    v_dot2_f32_bf16 v124, v125, v153, v124
    v_dot2_f32_bf16 v120, v122, v154, v120
    v_dot2_f32_bf16 v124, v126, v154, v124
    v_dot2_f32_bf16 v120, v123, v155, v120
    v_dot2_f32_bf16 v124, v127, v155, v124
    s_nop 1
    v_add_f32_dpp v120, v120, v120 row_ror:8 row_mask:0xf bank_mask:0xf
    v_add_f32_dpp v124, v124, v124 row_ror:8 row_mask:0xf bank_mask:0xf
    s_nop 0
    v_add_f32_dpp v120, v120, v120 row_ror:4 row_mask:0xf bank_mask:0xf
    v_add_f32_dpp v124, v124, v124 row_ror:4 row_mask:0xf bank_mask:0xf
    s_nop 0
    v_add_f32_dpp v120, v120, v120 row_ror:2 row_mask:0xf bank_mask:0xf
    v_add_f32_dpp v124, v124, v124 row_ror:2 row_mask:0xf bank_mask:0xf
    s_nop 0
    v_add_f32_dpp v120, v120, v120 row_ror:1 row_mask:0xf bank_mask:0xf
    v_add_f32_dpp v124, v124, v124 row_ror:1 row_mask:0xf bank_mask:0xf
    v_cvt_pk_bf16_f32 v14, v120, v124
    v_lshlrev_b32 v120, 16, v14
    v_and_b32 v124, s78, v14
    v_mul_f32 v120, 0x3db504f3, v120
    v_mul_f32 v124, 0x3db504f3, v124
    v_cvt_pk_bf16_f32 v14, v120, v124
    v_lshlrev_b32 v120, 16, v14
    v_and_b32 v124, s78, v14
    v_max3_f32 v14, v120, v124, v12
    v_mov_b32 v15, v14
    s_nop 1
    v_permlane16_swap_b32 v14, v15
    v_max_f32 v14, v14, v15
    v_mov_b32 v15, v14
    s_nop 1
    v_permlane32_swap_b32 v14, v15
    v_max_f32 v14, v14, v15
    v_sub_f32 v15, v12, v14
    v_sub_f32 v120, v120, v14
    v_sub_f32 v124, v124, v14
    v_mul_f32 v15, 0x3fb8aa3b, v15
    v_mul_f32 v120, 0x3fb8aa3b, v120
    v_mul_f32 v124, 0x3fb8aa3b, v124
    v_mov_b32 v12, v14
    v_exp_f32 v14, v15
    v_exp_f32 v120, v120
    v_exp_f32 v124, v124
    v_pk_mul_f32 v[16:17], v[16:17], v[14:15] op_sel_hi:[1,0]
    v_pk_mul_f32 v[18:19], v[18:19], v[14:15] op_sel_hi:[1,0]
    v_pk_mul_f32 v[20:21], v[20:21], v[14:15] op_sel_hi:[1,0]
    v_pk_mul_f32 v[22:23], v[22:23], v[14:15] op_sel_hi:[1,0]
    v_fma_f32 v13, v13, v14, v120
    v_add_f32 v13, v13, v124
    v_cvt_pk_bf16_f32 v121, 0, v120
    v_cvt_pk_bf16_f32 v120, v120, 0
    v_cvt_pk_bf16_f32 v125, 0, v124
    v_cvt_pk_bf16_f32 v124, v124, 0
    v_dot2c_f32_bf16 v16, v120, v128
    v_dot2c_f32_bf16 v17, v121, v128
    v_dot2c_f32_bf16 v18, v120, v129
    v_dot2c_f32_bf16 v19, v121, v129
    v_dot2c_f32_bf16 v20, v120, v130
    v_dot2c_f32_bf16 v21, v121, v130
    v_dot2c_f32_bf16 v22, v120, v131
    v_dot2c_f32_bf16 v23, v121, v131
    v_dot2c_f32_bf16 v16, v124, v132
    v_dot2c_f32_bf16 v17, v125, v132
    v_dot2c_f32_bf16 v18, v124, v133
    v_dot2c_f32_bf16 v19, v125, v133
    v_dot2c_f32_bf16 v20, v124, v134
    v_dot2c_f32_bf16 v21, v125, v134
    v_dot2c_f32_bf16 v22, v124, v135
    v_dot2c_f32_bf16 v23, v125, v135
    s_cmp_ge_u32 s71, s69
    s_nop 0
    s_cbranch_scc1 L_dynd_5
    s_waitcnt vmcnt(0)
    v_readfirstlane_b32 s70, v0
    s_nop 0
    s_cmp_ge_u32 s70, s69
    s_nop 1
    s_cbranch_scc1 L_dyns_7
    s_lshl_b32 s11, s70, 10
    buffer_load_dwordx4 v[120:123], v4, s[52:55], s11 offen offset:0 nt
    buffer_load_dwordx4 v[124:127], v4, s[52:55], s11 offen offset:1024 nt
    buffer_load_dwordx4 v[128:131], v4, s[56:59], s11 offen offset:0 nt
    buffer_load_dwordx4 v[132:135], v4, s[56:59], s11 offen offset:1024 nt
    v_mov_b32 v0, 2
    s_mov_b64 exec, 1
    buffer_atomic_add v0, v10, s[48:51], s68 offen sc0 sc1
    s_mov_b64 exec, -1
L_dyns_7:
    v_dot2_f32_bf16 v136, v136, v152, 0
    v_dot2_f32_bf16 v140, v140, v152, 0
    v_dot2_f32_bf16 v136, v137, v153, v136
    v_dot2_f32_bf16 v140, v141, v153, v140
    v_dot2_f32_bf16 v136, v138, v154, v136
    v_dot2_f32_bf16 v140, v142, v154, v140
    v_dot2_f32_bf16 v136, v139, v155, v136
    v_dot2_f32_bf16 v140, v143, v155, v140
    s_nop 1
    v_add_f32_dpp v136, v136, v136 row_ror:8 row_mask:0xf bank_mask:0xf
    v_add_f32_dpp v140, v140, v140 row_ror:8 row_mask:0xf bank_mask:0xf
    s_nop 0
    v_add_f32_dpp v136, v136, v136 row_ror:4 row_mask:0xf bank_mask:0xf
    v_add_f32_dpp v140, v140, v140 row_ror:4 row_mask:0xf bank_mask:0xf
    s_nop 0
    v_add_f32_dpp v136, v136, v136 row_ror:2 row_mask:0xf bank_mask:0xf
    v_add_f32_dpp v140, v140, v140 row_ror:2 row_mask:0xf bank_mask:0xf
    s_nop 0
    v_add_f32_dpp v136, v136, v136 row_ror:1 row_mask:0xf bank_mask:0xf
    v_add_f32_dpp v140, v140, v140 row_ror:1 row_mask:0xf bank_mask:0xf
    v_cvt_pk_bf16_f32 v14, v136, v140
    v_lshlrev_b32 v136, 16, v14
    v_and_b32 v140, s78, v14
    v_mul_f32 v136, 0x3db504f3, v136
    v_mul_f32 v140, 0x3db504f3, v140
    v_cvt_pk_bf16_f32 v14, v136, v140
    v_lshlrev_b32 v136, 16, v14
    v_and_b32 v140, s78, v14
    v_max3_f32 v14, v136, v140, v12
    v_mov_b32 v15, v14
    s_nop 1
    v_permlane16_swap_b32 v14, v15
    v_max_f32 v14, v14, v15
    v_mov_b32 v15, v14
    s_nop 1
    v_permlane32_swap_b32 v14, v15
    v_max_f32 v14, v14, v15
    v_sub_f32 v15, v12, v14
    v_sub_f32 v136, v136, v14
    v_sub_f32 v140, v140, v14
    v_mul_f32 v15, 0x3fb8aa3b, v15
    v_mul_f32 v136, 0x3fb8aa3b, v136
    v_mul_f32 v140, 0x3fb8aa3b, v140
    v_mov_b32 v12, v14
    v_exp_f32 v14, v15
    v_exp_f32 v136, v136
    v_exp_f32 v140, v140
    v_pk_mul_f32 v[16:17], v[16:17], v[14:15] op_sel_hi:[1,0]
    v_pk_mul_f32 v[18:19], v[18:19], v[14:15] op_sel_hi:[1,0]
    v_pk_mul_f32 v[20:21], v[20:21], v[14:15] op_sel_hi:[1,0]
    v_pk_mul_f32 v[22:23], v[22:23], v[14:15] op_sel_hi:[1,0]
    v_fma_f32 v13, v13, v14, v136
    v_add_f32 v13, v13, v140
    v_cvt_pk_bf16_f32 v137, 0, v136
    v_cvt_pk_bf16_f32 v136, v136, 0
    v_cvt_pk_bf16_f32 v141, 0, v140
    v_cvt_pk_bf16_f32 v140, v140, 0
    v_dot2c_f32_bf16 v16, v136, v144
    v_dot2c_f32_bf16 v17, v137, v144
    v_dot2c_f32_bf16 v18, v136, v145
    v_dot2c_f32_bf16 v19, v137, v145
    v_dot2c_f32_bf16 v20, v136, v146
    v_dot2c_f32_bf16 v21, v137, v146
    v_dot2c_f32_bf16 v22, v136, v147
    v_dot2c_f32_bf16 v23, v137, v147
    v_dot2c_f32_bf16 v16, v140, v148
    v_dot2c_f32_bf16 v17, v141, v148
    v_dot2c_f32_bf16 v18, v140, v149
    v_dot2c_f32_bf16 v19, v141, v149
    v_dot2c_f32_bf16 v20, v140, v150
    v_dot2c_f32_bf16 v21, v141, v150
    v_dot2c_f32_bf16 v22, v140, v151
    v_dot2c_f32_bf16 v23, v141, v151
    s_nop 1
    s_branch L_dyn_4
L_dynd_5:
    s_waitcnt vmcnt(1)
    v_mov_b32 v15, v13
    s_nop 1
    v_permlane16_swap_b32 v13, v15
    v_add_f32 v13, v13, v15
    v_mov_b32 v15, v13
    s_nop 1
    v_permlane32_swap_b32 v13, v15
    v_add_f32 v13, v13, v15
    v_permlane32_swap_b32 v16, v20
    v_permlane32_swap_b32 v17, v21
    v_permlane32_swap_b32 v18, v22
    v_permlane32_swap_b32 v19, v23
    v_add_f32 v16, v16, v20
    v_add_f32 v17, v17, v21
    v_add_f32 v18, v18, v22
    v_add_f32 v19, v19, v23
    s_nop 0
    v_permlane16_swap_b32 v16, v18
    v_permlane16_swap_b32 v17, v19
    v_add_f32 v16, v16, v18
    v_add_f32 v17, v17, v19
    s_lshl_b32 s13, s3, 3
    v_mov_b32 v14, s13
    ds_write_b64 v3, v[16:17] offset:1024
    s_mov_b64 exec, 1
    ds_write_b64 v14, v[12:13] offset:320
    ds_add_rtn_u32 v12, v10, v11 offset:12
    s_mov_b32 exec_lo, -1
    v_and_b32 v14, 7, v1
    v_lshlrev_b32 v14, 3, v14
    s_waitcnt lgkmcnt(0)
    v_readfirstlane_b32 s12, v12
    s_nop 0
    s_cmp_lg_u32 s12, 7
    s_nop 1
    s_cbranch_scc1 L_oxd_8
    ds_read_b64 v[12:13], v14 offset:320
    ds_read_b128 v[156:159], v4 offset:1024
    ds_read_b128 v[160:163], v4 offset:1536
    ds_read_b128 v[164:167], v4 offset:2048
    ds_read_b128 v[24:27], v4 offset:2560
    ds_read_b128 v[28:31], v4 offset:3072
    ds_read_b128 v[32:35], v4 offset:3584
    ds_read_b128 v[36:39], v4 offset:4096
    ds_read_b128 v[40:43], v4 offset:4608
    s_waitcnt lgkmcnt(8)
    v_max_f32_dpp v14, v12, v12 quad_perm:[1,0,3,2] row_mask:0xf bank_mask:0xf
    s_nop 1
    v_max_f32_dpp v14, v14, v14 quad_perm:[2,3,0,1] row_mask:0xf bank_mask:0xf
    s_nop 1
    v_max_f32_dpp v14, v14, v14 row_half_mirror row_mask:0xf bank_mask:0xf
    v_sub_f32 v12, v12, v14
    v_mul_f32 v12, 0x3fb8aa3b, v12
    v_exp_f32 v12, v12
    s_lshl_b32 s13, s8, 4
    s_add_u32 s13, s13, 0x50000
    v_mul_f32 v15, v13, v12
    v_min_u32 v14, -2, v14
    s_nop 0
    v_add_f32_dpp v15, v15, v15 quad_perm:[1,0,3,2] row_mask:0xf bank_mask:0xf
    s_nop 1
    v_add_f32_dpp v15, v15, v15 quad_perm:[2,3,0,1] row_mask:0xf bank_mask:0xf
    s_nop 1
    v_add_f32_dpp v15, v15, v15 row_half_mirror row_mask:0xf bank_mask:0xf
    v_min_u32 v15, -2, v15
    s_mov_b64 exec, 1
    buffer_store_dwordx2 v[14:15], v10, s[48:51], s13 offen sc1
    s_mov_b32 exec_lo, -1
    s_waitcnt lgkmcnt(6)
    v_mul_f32_dpp v16, v12, v156 row_newbcast:0 row_mask:0xf bank_mask:0xf
    v_mul_f32_dpp v17, v12, v157 row_newbcast:0 row_mask:0xf bank_mask:0xf
    v_mul_f32_dpp v18, v12, v158 row_newbcast:0 row_mask:0xf bank_mask:0xf
    v_mul_f32_dpp v19, v12, v159 row_newbcast:0 row_mask:0xf bank_mask:0xf
    v_fmac_f32_dpp v16, v12, v160 row_newbcast:1 row_mask:0xf bank_mask:0xf
    v_fmac_f32_dpp v17, v12, v161 row_newbcast:1 row_mask:0xf bank_mask:0xf
    v_fmac_f32_dpp v18, v12, v162 row_newbcast:1 row_mask:0xf bank_mask:0xf
    v_fmac_f32_dpp v19, v12, v163 row_newbcast:1 row_mask:0xf bank_mask:0xf
    s_waitcnt lgkmcnt(4)
    v_fmac_f32_dpp v16, v12, v164 row_newbcast:2 row_mask:0xf bank_mask:0xf
    v_fmac_f32_dpp v17, v12, v165 row_newbcast:2 row_mask:0xf bank_mask:0xf
    v_fmac_f32_dpp v18, v12, v166 row_newbcast:2 row_mask:0xf bank_mask:0xf
    v_fmac_f32_dpp v19, v12, v167 row_newbcast:2 row_mask:0xf bank_mask:0xf
    v_fmac_f32_dpp v16, v12, v24 row_newbcast:3 row_mask:0xf bank_mask:0xf
    v_fmac_f32_dpp v17, v12, v25 row_newbcast:3 row_mask:0xf bank_mask:0xf
    v_fmac_f32_dpp v18, v12, v26 row_newbcast:3 row_mask:0xf bank_mask:0xf
    v_fmac_f32_dpp v19, v12, v27 row_newbcast:3 row_mask:0xf bank_mask:0xf
    s_waitcnt lgkmcnt(2)
    v_fmac_f32_dpp v16, v12, v28 row_newbcast:4 row_mask:0xf bank_mask:0xf
    v_fmac_f32_dpp v17, v12, v29 row_newbcast:4 row_mask:0xf bank_mask:0xf
    v_fmac_f32_dpp v18, v12, v30 row_newbcast:4 row_mask:0xf bank_mask:0xf
    v_fmac_f32_dpp v19, v12, v31 row_newbcast:4 row_mask:0xf bank_mask:0xf
    v_fmac_f32_dpp v16, v12, v32 row_newbcast:5 row_mask:0xf bank_mask:0xf
    v_fmac_f32_dpp v17, v12, v33 row_newbcast:5 row_mask:0xf bank_mask:0xf
    v_fmac_f32_dpp v18, v12, v34 row_newbcast:5 row_mask:0xf bank_mask:0xf
    v_fmac_f32_dpp v19, v12, v35 row_newbcast:5 row_mask:0xf bank_mask:0xf
    s_waitcnt lgkmcnt(0)
    v_fmac_f32_dpp v16, v12, v36 row_newbcast:6 row_mask:0xf bank_mask:0xf
    v_fmac_f32_dpp v17, v12, v37 row_newbcast:6 row_mask:0xf bank_mask:0xf
    v_fmac_f32_dpp v18, v12, v38 row_newbcast:6 row_mask:0xf bank_mask:0xf
    v_fmac_f32_dpp v19, v12, v39 row_newbcast:6 row_mask:0xf bank_mask:0xf
    v_fmac_f32_dpp v16, v12, v40 row_newbcast:7 row_mask:0xf bank_mask:0xf
    v_fmac_f32_dpp v17, v12, v41 row_newbcast:7 row_mask:0xf bank_mask:0xf
    v_fmac_f32_dpp v18, v12, v42 row_newbcast:7 row_mask:0xf bank_mask:0xf
    v_fmac_f32_dpp v19, v12, v43 row_newbcast:7 row_mask:0xf bank_mask:0xf
    v_min_u32 v16, -2, v16
    v_min_u32 v17, -2, v17
    v_min_u32 v18, -2, v18
    v_min_u32 v19, -2, v19
    v_min_u32 v15, -2, v15
    buffer_store_dwordx4 v[16:19], v4, s[48:51], s15 offen sc1
    s_nop 1
L_oxd_8:
    s_mov_b64 exec, -1
    s_waitcnt vmcnt(0)
    s_endpgm
L_attF:
    s_mov_b32 s11, 0x0
    buffer_load_dwordx4 v[24:27], v2, s[52:55], s11 offen nt
    s_mov_b32 s11, 0x2000
    buffer_load_dwordx4 v[28:31], v2, s[52:55], s11 offen nt
    s_mov_b32 s11, 0x4000
    buffer_load_dwordx4 v[32:35], v2, s[52:55], s11 offen nt
    s_mov_b32 s11, 0x6000
    buffer_load_dwordx4 v[36:39], v2, s[52:55], s11 offen nt
    s_add_u32 s56, s20, s12
    s_addc_u32 s57, s21, 0
    s_mov_b32 s58, s54
    s_mov_b32 s59, s55
    s_mov_b32 s48, s42
    s_mov_b32 s49, s43
    s_mov_b32 s50, 0x400000
    s_mov_b32 s51, 0x00020000
    s_sub_u32 s13, s9, 0
    s_bfm_b32 s60, s13, 0
    s_mul_i32 s60, s60, 0x10001
    s_mov_b32 s61, s60
    v_mov_b32 v16, 0
    v_mov_b32 v17, 0
    v_mov_b32 v18, 0
    v_mov_b32 v19, 0
    v_mov_b32 v20, 0
    v_mov_b32 v21, 0
    v_mov_b32 v22, 0
    v_mov_b32 v23, 0
    v_and_b32 v3, 15, v1
    v_lshlrev_b32 v13, 4, v3
    v_lshlrev_b32 v3, 5, v3
    v_lshrrev_b32 v5, 4, v1
    v_lshl_add_u32 v3, v5, 3, v3
    s_lshl_b32 s12, s3, 9
    v_add_u32 v3, s12, v3
    s_lshl_b32 s15, s8, 9
    s_add_u32 s15, s15, 0x60000
    s_waitcnt vmcnt(3)
    s_mov_b32 s11, 0x8000
    buffer_load_dwordx4 v[40:43], v2, s[52:55], s11 offen nt
    s_waitcnt vmcnt(3)
    s_mov_b32 s11, 0xa000
    buffer_load_dwordx4 v[44:47], v2, s[52:55], s11 offen nt
    s_waitcnt vmcnt(3)
    s_mov_b32 s11, 0xc000
    buffer_load_dwordx4 v[48:51], v2, s[52:55], s11 offen nt
    s_waitcnt vmcnt(3)
    s_mov_b32 s11, 0xe000
    buffer_load_dwordx4 v[52:55], v2, s[52:55], s11 offen nt
    s_waitcnt vmcnt(3)
    s_mov_b32 s11, 0x10000
    buffer_load_dwordx4 v[56:59], v2, s[52:55], s11 offen nt
    s_waitcnt vmcnt(3)
    s_mov_b32 s11, 0x12000
    buffer_load_dwordx4 v[60:63], v2, s[52:55], s11 offen nt
    s_waitcnt vmcnt(3)
    s_mov_b32 s11, 0x14000
    buffer_load_dwordx4 v[64:67], v2, s[52:55], s11 offen nt
    s_waitcnt vmcnt(3)
    s_mov_b32 s11, 0x16000
    buffer_load_dwordx4 v[68:71], v2, s[52:55], s11 offen nt
    s_waitcnt vmcnt(3)
    s_mov_b32 s11, 0x18000
    buffer_load_dwordx4 v[72:75], v2, s[52:55], s11 offen nt
    s_waitcnt vmcnt(3)
    s_mov_b32 s11, 0x1a000
    buffer_load_dwordx4 v[76:79], v2, s[52:55], s11 offen nt
    s_waitcnt vmcnt(3)
    s_mov_b32 s11, 0x0
    buffer_load_dwordx4 v[80:83], v2, s[56:59], s11 offen nt
    s_waitcnt vmcnt(3)
    s_mov_b32 s11, 0x2000
    buffer_load_dwordx4 v[84:87], v2, s[56:59], s11 offen nt
    s_waitcnt vmcnt(3)
    s_mov_b32 s11, 0x4000
    buffer_load_dwordx4 v[88:91], v2, s[56:59], s11 offen nt
    s_waitcnt vmcnt(3)
    s_mov_b32 s11, 0x6000
    buffer_load_dwordx4 v[92:95], v2, s[56:59], s11 offen nt
    s_waitcnt vmcnt(3)
    s_mov_b32 s11, 0x8000
    buffer_load_dwordx4 v[96:99], v2, s[56:59], s11 offen nt
    s_waitcnt vmcnt(3)
    s_mov_b32 s11, 0xa000
    buffer_load_dwordx4 v[100:103], v2, s[56:59], s11 offen nt
    s_waitcnt vmcnt(3)
    s_mov_b32 s11, 0xc000
    buffer_load_dwordx4 v[104:107], v2, s[56:59], s11 offen nt
    s_waitcnt vmcnt(3)
    s_mov_b32 s11, 0xe000
    buffer_load_dwordx4 v[108:111], v2, s[56:59], s11 offen nt
    s_waitcnt vmcnt(3)
    s_mov_b32 s11, 0x10000
    buffer_load_dwordx4 v[112:115], v2, s[56:59], s11 offen nt
    s_waitcnt vmcnt(3)
    s_mov_b32 s11, 0x12000
    buffer_load_dwordx4 v[116:119], v2, s[56:59], s11 offen nt
    s_waitcnt vmcnt(3)
    s_mov_b32 s11, 0x14000
    buffer_load_dwordx4 v[120:123], v2, s[56:59], s11 offen nt
    s_waitcnt vmcnt(3)
    s_mov_b32 s11, 0x16000
    buffer_load_dwordx4 v[124:127], v2, s[56:59], s11 offen nt
    s_waitcnt vmcnt(3)
    s_mov_b32 s11, 0x18000
    buffer_load_dwordx4 v[128:131], v2, s[56:59], s11 offen nt
    s_waitcnt vmcnt(3)
    s_mov_b32 s11, 0x1a000
    buffer_load_dwordx4 v[132:135], v2, s[56:59], s11 offen nt
    s_mul_i32 s9, s4, 9
    s_add_u32 s9, s9, s5
    s_lshr_b32 s79, s3, 1
    s_bitcmp0_b32 s3, 0
    s_cselect_b32 s12, s28, s30
    s_cselect_b32 s13, s29, s31
    s_lshl_b32 s14, s9, 7
    s_mul_i32 s46, s79, 1327104
    s_add_u32 s14, s14, s46
    s_add_u32 s64, s12, s14
    s_addc_u32 s65, s13, 0
    s_sub_u32 s66, 0x510000, s14
    s_mov_b32 s67, 0x00020000
    v_lshrrev_b32 v5, 4, v1
    v_mul_u32_u24 v5, 331776, v5
    v_and_b32 v14, 15, v1
    v_lshl_add_u32 v5, v14, 3, v5
    s_mov_b32 s11, 0
    buffer_load_dwordx2 v[136:137], v5, s[64:67], s11 offen nt
    s_mov_b32 s11, 9216
    buffer_load_dwordx2 v[138:139], v5, s[64:67], s11 offen nt
    s_waitcnt vmcnt(5)
    s_mov_b32 s11, 18432
    buffer_load_dwordx2 v[140:141], v5, s[64:67], s11 offen nt
    s_waitcnt vmcnt(5)
    s_mov_b32 s11, 27648
    buffer_load_dwordx2 v[142:143], v5, s[64:67], s11 offen nt
    s_waitcnt vmcnt(5)
    s_mov_b32 s11, 36864
    buffer_load_dwordx2 v[144:145], v5, s[64:67], s11 offen nt
    s_waitcnt vmcnt(5)
    s_mov_b32 s11, 46080
    buffer_load_dwordx2 v[146:147], v5, s[64:67], s11 offen nt
    s_waitcnt vmcnt(5)
    s_mov_b32 s11, 55296
    buffer_load_dwordx2 v[148:149], v5, s[64:67], s11 offen nt
    s_waitcnt vmcnt(5)
    s_mov_b32 s11, 64512
    buffer_load_dwordx2 v[150:151], v5, s[64:67], s11 offen nt
    s_waitcnt vmcnt(5)
    s_mov_b32 s11, 73728
    buffer_load_dwordx2 v[152:153], v5, s[64:67], s11 offen nt
    s_waitcnt vmcnt(5)
    s_mov_b32 s11, 82944
    buffer_load_dwordx2 v[154:155], v5, s[64:67], s11 offen nt
    s_waitcnt vmcnt(5)
    s_mov_b32 s11, 92160
    buffer_load_dwordx2 v[156:157], v5, s[64:67], s11 offen nt
    s_waitcnt vmcnt(5)
    s_mov_b32 s11, 101376
    buffer_load_dwordx2 v[158:159], v5, s[64:67], s11 offen nt
    s_waitcnt vmcnt(5)
    s_mov_b32 s11, 110592
    buffer_load_dwordx2 v[160:161], v5, s[64:67], s11 offen nt
    s_waitcnt vmcnt(5)
    s_mov_b32 s11, 119808
    buffer_load_dwordx2 v[162:163], v5, s[64:67], s11 offen nt
    s_waitcnt vmcnt(5)
    s_mov_b32 s11, 129024
    buffer_load_dwordx2 v[164:165], v5, s[64:67], s11 offen nt
    s_waitcnt vmcnt(5)
    s_mov_b32 s11, 138240
    buffer_load_dwordx2 v[166:167], v5, s[64:67], s11 offen nt
    s_waitcnt lgkmcnt(0)
    s_add_u32 s44, s44, 0x7f4a7c15
    s_addc_u32 s45, s45, 0x9e3779b9
L_fw_9:
    ds_read_b32 v12, v10 offset:0
    s_waitcnt lgkmcnt(0)
    v_readfirstlane_b32 s12, v12
    s_nop 0
    s_cmp_lg_u32 s12, 0
    s_nop 1
    s_cbranch_scc1 L_fwd_10
    s_sleep 2
    s_branch L_fw_9
L_fwd_10:
    ds_read_b128 v[12:15], v13 offset:64
    s_waitcnt lgkmcnt(0)
    v_mov_b32 v7, 0xff800000
    v_dot2_f32_bf16 v24, v24, v12, 0
    v_dot2_f32_bf16 v28, v28, v12, 0
    v_dot2_f32_bf16 v32, v32, v12, 0
    v_dot2_f32_bf16 v36, v36, v12, 0
    v_dot2_f32_bf16 v24, v25, v13, v24
    v_dot2_f32_bf16 v28, v29, v13, v28
    v_dot2_f32_bf16 v32, v33, v13, v32
    v_dot2_f32_bf16 v36, v37, v13, v36
    v_dot2_f32_bf16 v24, v26, v14, v24
    v_dot2_f32_bf16 v28, v30, v14, v28
    v_dot2_f32_bf16 v32, v34, v14, v32
    v_dot2_f32_bf16 v36, v38, v14, v36
    v_dot2_f32_bf16 v24, v27, v15, v24
    v_dot2_f32_bf16 v28, v31, v15, v28
    v_dot2_f32_bf16 v32, v35, v15, v32
    v_dot2_f32_bf16 v36, v39, v15, v36
    v_dot2_f32_bf16 v40, v40, v12, 0
    v_dot2_f32_bf16 v44, v44, v12, 0
    v_dot2_f32_bf16 v48, v48, v12, 0
    v_dot2_f32_bf16 v52, v52, v12, 0
    v_dot2_f32_bf16 v40, v41, v13, v40
    v_dot2_f32_bf16 v44, v45, v13, v44
    v_dot2_f32_bf16 v48, v49, v13, v48
    v_dot2_f32_bf16 v52, v53, v13, v52
    v_dot2_f32_bf16 v40, v42, v14, v40
    v_dot2_f32_bf16 v44, v46, v14, v44
    v_dot2_f32_bf16 v48, v50, v14, v48
    v_dot2_f32_bf16 v52, v54, v14, v52
    v_dot2_f32_bf16 v40, v43, v15, v40
    v_dot2_f32_bf16 v44, v47, v15, v44
    v_dot2_f32_bf16 v48, v51, v15, v48
    v_dot2_f32_bf16 v52, v55, v15, v52
    v_dot2_f32_bf16 v56, v56, v12, 0
    v_dot2_f32_bf16 v60, v60, v12, 0
    v_dot2_f32_bf16 v64, v64, v12, 0
    v_dot2_f32_bf16 v68, v68, v12, 0
    v_dot2_f32_bf16 v56, v57, v13, v56
    v_dot2_f32_bf16 v60, v61, v13, v60
    v_dot2_f32_bf16 v64, v65, v13, v64
    v_dot2_f32_bf16 v68, v69, v13, v68
    v_dot2_f32_bf16 v56, v58, v14, v56
    v_dot2_f32_bf16 v60, v62, v14, v60
    v_dot2_f32_bf16 v64, v66, v14, v64
    v_dot2_f32_bf16 v68, v70, v14, v68
    v_dot2_f32_bf16 v56, v59, v15, v56
    v_dot2_f32_bf16 v60, v63, v15, v60
    v_dot2_f32_bf16 v64, v67, v15, v64
    v_dot2_f32_bf16 v68, v71, v15, v68
    v_dot2_f32_bf16 v72, v72, v12, 0
    v_dot2_f32_bf16 v76, v76, v12, 0
    v_dot2_f32_bf16 v72, v73, v13, v72
    v_dot2_f32_bf16 v76, v77, v13, v76
    v_dot2_f32_bf16 v72, v74, v14, v72
    v_dot2_f32_bf16 v76, v78, v14, v76
    v_dot2_f32_bf16 v72, v75, v15, v72
    v_dot2_f32_bf16 v76, v79, v15, v76
    v_add_f32_dpp v24, v24, v24 row_ror:8 row_mask:0xf bank_mask:0x3
    v_add_f32_dpp v28, v28, v28 row_ror:8 row_mask:0xf bank_mask:0x3
    v_add_f32_dpp v32, v32, v32 row_ror:8 row_mask:0xf bank_mask:0x3
    v_add_f32_dpp v36, v36, v36 row_ror:8 row_mask:0xf bank_mask:0x3
    v_add_f32_dpp v40, v40, v40 row_ror:8 row_mask:0xf bank_mask:0x3
    v_add_f32_dpp v44, v44, v44 row_ror:8 row_mask:0xf bank_mask:0x3
    v_add_f32_dpp v48, v48, v48 row_ror:8 row_mask:0xf bank_mask:0x3
    v_add_f32_dpp v52, v52, v52 row_ror:8 row_mask:0xf bank_mask:0x3
    v_add_f32_dpp v24, v56, v56 row_ror:8 row_mask:0xf bank_mask:0xc
    v_add_f32_dpp v28, v60, v60 row_ror:8 row_mask:0xf bank_mask:0xc
    v_add_f32_dpp v32, v64, v64 row_ror:8 row_mask:0xf bank_mask:0xc
    v_add_f32_dpp v36, v68, v68 row_ror:8 row_mask:0xf bank_mask:0xc
    v_add_f32_dpp v40, v72, v72 row_ror:8 row_mask:0xf bank_mask:0xc
    v_add_f32_dpp v44, v76, v76 row_ror:8 row_mask:0xf bank_mask:0xc
    v_add_f32_dpp v24, v24, v24 row_shl:4 row_mask:0xf bank_mask:0x5
    v_add_f32_dpp v28, v28, v28 row_shl:4 row_mask:0xf bank_mask:0x5
    v_add_f32_dpp v32, v32, v32 row_shl:4 row_mask:0xf bank_mask:0x5
    v_add_f32_dpp v36, v36, v36 row_shl:4 row_mask:0xf bank_mask:0x5
    v_add_f32_dpp v24, v40, v40 row_shr:4 row_mask:0xf bank_mask:0xa
    v_add_f32_dpp v28, v44, v44 row_shr:4 row_mask:0xf bank_mask:0xa
    v_add_f32_dpp v32, v48, v48 row_shr:4 row_mask:0xf bank_mask:0xa
    v_add_f32_dpp v36, v52, v52 row_shr:4 row_mask:0xf bank_mask:0xa
    v_add_f32_dpp v24, v24, v24 quad_perm:[2,3,0,1] row_mask:0xf bank_mask:0xf
    v_add_f32_dpp v28, v28, v28 quad_perm:[2,3,0,1] row_mask:0xf bank_mask:0xf
    v_add_f32_dpp v32, v32, v32 quad_perm:[2,3,0,1] row_mask:0xf bank_mask:0xf
    v_add_f32_dpp v36, v36, v36 quad_perm:[2,3,0,1] row_mask:0xf bank_mask:0xf
    v_cndmask_b32 v24, v24, v32, s[72:73]
    v_cndmask_b32 v28, v28, v36, s[72:73]
    s_nop 0
    v_add_f32_dpp v24, v24, v24 quad_perm:[1,0,3,2] row_mask:0xf bank_mask:0xf
    v_add_f32_dpp v28, v28, v28 quad_perm:[1,0,3,2] row_mask:0xf bank_mask:0xf
    v_mov_b32 v25, 0xff800000
    v_cndmask_b32 v24, v24, v28, s[74:75]
    v_cndmask_b32 v6, v25, v24, s[60:61]
    v_cvt_pk_bf16_f32 v14, v6, v7
    v_lshlrev_b32 v6, 16, v14
    v_and_b32 v7, s78, v14
    v_mul_f32 v6, 0x3db504f3, v6
    v_mul_f32 v7, 0x3db504f3, v7
    v_cvt_pk_bf16_f32 v14, v6, v7
    v_lshlrev_b32 v6, 16, v14
    v_and_b32 v7, s78, v14
    v_max_f32 v12, v6, v7
    s_nop 1
    v_max_f32_dpp v12, v12, v12 row_ror:8 row_mask:0xf bank_mask:0xf
    s_nop 1
    v_max_f32_dpp v12, v12, v12 row_ror:4 row_mask:0xf bank_mask:0xf
    s_nop 1
    v_max_f32_dpp v12, v12, v12 row_ror:2 row_mask:0xf bank_mask:0xf
    s_nop 1
    v_max_f32_dpp v12, v12, v12 row_ror:1 row_mask:0xf bank_mask:0xf
    v_mov_b32 v14, v12
    s_nop 1
    v_permlane16_swap_b32 v12, v14
    v_max_f32 v12, v12, v14
    v_mov_b32 v14, v12
    s_nop 1
    v_permlane32_swap_b32 v12, v14
    v_max_f32 v12, v12, v14
    v_sub_f32 v6, v6, v12
    v_sub_f32 v7, v7, v12
    v_mul_f32 v6, 0x3fb8aa3b, v6
    v_mul_f32 v7, 0x3fb8aa3b, v7
    v_exp_f32 v6, v6
    v_exp_f32 v7, v7
    s_nop 0
    v_add_f32 v13, v6, v7
    v_cvt_pk_bf16_f32 v8, 0, v6
    v_cvt_pk_bf16_f32 v9, 0, v7
    v_cvt_pk_bf16_f32 v6, v6, 0
    v_cvt_pk_bf16_f32 v7, v7, 0
    v_add_f32_dpp v13, v13, v13 row_ror:8 row_mask:0xf bank_mask:0xf
    s_nop 1
    v_add_f32_dpp v13, v13, v13 row_ror:4 row_mask:0xf bank_mask:0xf
    s_nop 1
    v_add_f32_dpp v13, v13, v13 row_ror:2 row_mask:0xf bank_mask:0xf
    s_nop 1
    v_add_f32_dpp v13, v13, v13 row_ror:1 row_mask:0xf bank_mask:0xf
    v_mov_b32 v14, v13
    s_nop 1
    v_permlane16_swap_b32 v13, v14
    v_add_f32 v13, v13, v14
    v_mov_b32 v14, v13
    s_nop 1
    v_permlane32_swap_b32 v13, v14
    v_add_f32 v13, v13, v14
    v_mul_f32 v13, 0.25, v13
    s_and_b32 s14, s6, 3
    s_lshl_b32 s14, s14, 3
    s_lshr_b32 s12, 0xc6c5c7bd, s14
    s_and_b32 s12, s12, 0xff
    s_sub_u32 s69, 256, s12
    s_lshl_b32 s69, s69, 3
    s_lshl_b32 s12, s12, 13
    s_lshl_b32 s13, s6, 21
    s_add_u32 s47, s12, s13
    s_lshl_b32 s68, s6, 8
    s_add_u32 s68, s68, 0x54000
    s_lshl_b32 s14, s9, 3
    s_add_u32 s14, s14, s3
    s_mul_i32 s14, s14, 9216
    s_add_u32 s60, s32, s14
    s_addc_u32 s61, s33, 0
    s_sub_u32 s62, 0x510000, s14
    s_mov_b32 s63, 0x00020000
    s_waitcnt vmcnt(5)
    s_mov_b32 s11, 147456
    buffer_load_dwordx2 v[24:25], v5, s[64:67], s11 offen nt
    v_dot2c_f32_bf16_dpp v16, v6, v80 row_newbcast:0 row_mask:0xf bank_mask:0xf
    v_dot2c_f32_bf16_dpp v17, v8, v80 row_newbcast:0 row_mask:0xf bank_mask:0xf
    v_dot2c_f32_bf16_dpp v18, v6, v81 row_newbcast:0 row_mask:0xf bank_mask:0xf
    v_dot2c_f32_bf16_dpp v19, v8, v81 row_newbcast:0 row_mask:0xf bank_mask:0xf
    v_dot2c_f32_bf16_dpp v20, v6, v82 row_newbcast:0 row_mask:0xf bank_mask:0xf
    v_dot2c_f32_bf16_dpp v21, v8, v82 row_newbcast:0 row_mask:0xf bank_mask:0xf
    v_dot2c_f32_bf16_dpp v22, v6, v83 row_newbcast:0 row_mask:0xf bank_mask:0xf
    v_dot2c_f32_bf16_dpp v23, v8, v83 row_newbcast:0 row_mask:0xf bank_mask:0xf
    v_dot2c_f32_bf16_dpp v16, v6, v84 row_newbcast:1 row_mask:0xf bank_mask:0xf
    v_dot2c_f32_bf16_dpp v17, v8, v84 row_newbcast:1 row_mask:0xf bank_mask:0xf
    v_dot2c_f32_bf16_dpp v18, v6, v85 row_newbcast:1 row_mask:0xf bank_mask:0xf
    v_dot2c_f32_bf16_dpp v19, v8, v85 row_newbcast:1 row_mask:0xf bank_mask:0xf
    v_dot2c_f32_bf16_dpp v20, v6, v86 row_newbcast:1 row_mask:0xf bank_mask:0xf
    v_dot2c_f32_bf16_dpp v21, v8, v86 row_newbcast:1 row_mask:0xf bank_mask:0xf
    v_dot2c_f32_bf16_dpp v22, v6, v87 row_newbcast:1 row_mask:0xf bank_mask:0xf
    v_dot2c_f32_bf16_dpp v23, v8, v87 row_newbcast:1 row_mask:0xf bank_mask:0xf
    s_waitcnt vmcnt(5)
    s_mov_b32 s11, 156672
    buffer_load_dwordx2 v[26:27], v5, s[64:67], s11 offen nt
    v_dot2c_f32_bf16_dpp v16, v6, v88 row_newbcast:2 row_mask:0xf bank_mask:0xf
    v_dot2c_f32_bf16_dpp v17, v8, v88 row_newbcast:2 row_mask:0xf bank_mask:0xf
    v_dot2c_f32_bf16_dpp v18, v6, v89 row_newbcast:2 row_mask:0xf bank_mask:0xf
    v_dot2c_f32_bf16_dpp v19, v8, v89 row_newbcast:2 row_mask:0xf bank_mask:0xf
    v_dot2c_f32_bf16_dpp v20, v6, v90 row_newbcast:2 row_mask:0xf bank_mask:0xf
    v_dot2c_f32_bf16_dpp v21, v8, v90 row_newbcast:2 row_mask:0xf bank_mask:0xf
    v_dot2c_f32_bf16_dpp v22, v6, v91 row_newbcast:2 row_mask:0xf bank_mask:0xf
    v_dot2c_f32_bf16_dpp v23, v8, v91 row_newbcast:2 row_mask:0xf bank_mask:0xf
    v_dot2c_f32_bf16_dpp v16, v6, v92 row_newbcast:3 row_mask:0xf bank_mask:0xf
    v_dot2c_f32_bf16_dpp v17, v8, v92 row_newbcast:3 row_mask:0xf bank_mask:0xf
    v_dot2c_f32_bf16_dpp v18, v6, v93 row_newbcast:3 row_mask:0xf bank_mask:0xf
    v_dot2c_f32_bf16_dpp v19, v8, v93 row_newbcast:3 row_mask:0xf bank_mask:0xf
    v_dot2c_f32_bf16_dpp v20, v6, v94 row_newbcast:3 row_mask:0xf bank_mask:0xf
    v_dot2c_f32_bf16_dpp v21, v8, v94 row_newbcast:3 row_mask:0xf bank_mask:0xf
    v_dot2c_f32_bf16_dpp v22, v6, v95 row_newbcast:3 row_mask:0xf bank_mask:0xf
    v_dot2c_f32_bf16_dpp v23, v8, v95 row_newbcast:3 row_mask:0xf bank_mask:0xf
    s_waitcnt vmcnt(5)
    s_mov_b32 s11, 165888
    buffer_load_dwordx2 v[28:29], v5, s[64:67], s11 offen nt
    v_dot2c_f32_bf16_dpp v16, v6, v96 row_newbcast:4 row_mask:0xf bank_mask:0xf
    v_dot2c_f32_bf16_dpp v17, v8, v96 row_newbcast:4 row_mask:0xf bank_mask:0xf
    v_dot2c_f32_bf16_dpp v18, v6, v97 row_newbcast:4 row_mask:0xf bank_mask:0xf
    v_dot2c_f32_bf16_dpp v19, v8, v97 row_newbcast:4 row_mask:0xf bank_mask:0xf
    v_dot2c_f32_bf16_dpp v20, v6, v98 row_newbcast:4 row_mask:0xf bank_mask:0xf
    v_dot2c_f32_bf16_dpp v21, v8, v98 row_newbcast:4 row_mask:0xf bank_mask:0xf
    v_dot2c_f32_bf16_dpp v22, v6, v99 row_newbcast:4 row_mask:0xf bank_mask:0xf
    v_dot2c_f32_bf16_dpp v23, v8, v99 row_newbcast:4 row_mask:0xf bank_mask:0xf
    v_dot2c_f32_bf16_dpp v16, v6, v100 row_newbcast:5 row_mask:0xf bank_mask:0xf
    v_dot2c_f32_bf16_dpp v17, v8, v100 row_newbcast:5 row_mask:0xf bank_mask:0xf
    v_dot2c_f32_bf16_dpp v18, v6, v101 row_newbcast:5 row_mask:0xf bank_mask:0xf
    v_dot2c_f32_bf16_dpp v19, v8, v101 row_newbcast:5 row_mask:0xf bank_mask:0xf
    v_dot2c_f32_bf16_dpp v20, v6, v102 row_newbcast:5 row_mask:0xf bank_mask:0xf
    v_dot2c_f32_bf16_dpp v21, v8, v102 row_newbcast:5 row_mask:0xf bank_mask:0xf
    v_dot2c_f32_bf16_dpp v22, v6, v103 row_newbcast:5 row_mask:0xf bank_mask:0xf
    v_dot2c_f32_bf16_dpp v23, v8, v103 row_newbcast:5 row_mask:0xf bank_mask:0xf
    s_waitcnt vmcnt(5)
    s_mov_b32 s11, 175104
    buffer_load_dwordx2 v[30:31], v5, s[64:67], s11 offen nt
    v_dot2c_f32_bf16_dpp v16, v6, v104 row_newbcast:6 row_mask:0xf bank_mask:0xf
    v_dot2c_f32_bf16_dpp v17, v8, v104 row_newbcast:6 row_mask:0xf bank_mask:0xf
    v_dot2c_f32_bf16_dpp v18, v6, v105 row_newbcast:6 row_mask:0xf bank_mask:0xf
    v_dot2c_f32_bf16_dpp v19, v8, v105 row_newbcast:6 row_mask:0xf bank_mask:0xf
    v_dot2c_f32_bf16_dpp v20, v6, v106 row_newbcast:6 row_mask:0xf bank_mask:0xf
    v_dot2c_f32_bf16_dpp v21, v8, v106 row_newbcast:6 row_mask:0xf bank_mask:0xf
    v_dot2c_f32_bf16_dpp v22, v6, v107 row_newbcast:6 row_mask:0xf bank_mask:0xf
    v_dot2c_f32_bf16_dpp v23, v8, v107 row_newbcast:6 row_mask:0xf bank_mask:0xf
    v_dot2c_f32_bf16_dpp v16, v6, v108 row_newbcast:7 row_mask:0xf bank_mask:0xf
    v_dot2c_f32_bf16_dpp v17, v8, v108 row_newbcast:7 row_mask:0xf bank_mask:0xf
    v_dot2c_f32_bf16_dpp v18, v6, v109 row_newbcast:7 row_mask:0xf bank_mask:0xf
    v_dot2c_f32_bf16_dpp v19, v8, v109 row_newbcast:7 row_mask:0xf bank_mask:0xf
    v_dot2c_f32_bf16_dpp v20, v6, v110 row_newbcast:7 row_mask:0xf bank_mask:0xf
    v_dot2c_f32_bf16_dpp v21, v8, v110 row_newbcast:7 row_mask:0xf bank_mask:0xf
    v_dot2c_f32_bf16_dpp v22, v6, v111 row_newbcast:7 row_mask:0xf bank_mask:0xf
    v_dot2c_f32_bf16_dpp v23, v8, v111 row_newbcast:7 row_mask:0xf bank_mask:0xf
    s_waitcnt vmcnt(5)
    s_mov_b32 s11, 184320
    buffer_load_dwordx2 v[32:33], v5, s[64:67], s11 offen nt
    v_dot2c_f32_bf16_dpp v16, v6, v112 row_newbcast:8 row_mask:0xf bank_mask:0xf
    v_dot2c_f32_bf16_dpp v17, v8, v112 row_newbcast:8 row_mask:0xf bank_mask:0xf
    v_dot2c_f32_bf16_dpp v18, v6, v113 row_newbcast:8 row_mask:0xf bank_mask:0xf
    v_dot2c_f32_bf16_dpp v19, v8, v113 row_newbcast:8 row_mask:0xf bank_mask:0xf
    v_dot2c_f32_bf16_dpp v20, v6, v114 row_newbcast:8 row_mask:0xf bank_mask:0xf
    v_dot2c_f32_bf16_dpp v21, v8, v114 row_newbcast:8 row_mask:0xf bank_mask:0xf
    v_dot2c_f32_bf16_dpp v22, v6, v115 row_newbcast:8 row_mask:0xf bank_mask:0xf
    v_dot2c_f32_bf16_dpp v23, v8, v115 row_newbcast:8 row_mask:0xf bank_mask:0xf
    v_dot2c_f32_bf16_dpp v16, v6, v116 row_newbcast:9 row_mask:0xf bank_mask:0xf
    v_dot2c_f32_bf16_dpp v17, v8, v116 row_newbcast:9 row_mask:0xf bank_mask:0xf
    v_dot2c_f32_bf16_dpp v18, v6, v117 row_newbcast:9 row_mask:0xf bank_mask:0xf
    v_dot2c_f32_bf16_dpp v19, v8, v117 row_newbcast:9 row_mask:0xf bank_mask:0xf
    v_dot2c_f32_bf16_dpp v20, v6, v118 row_newbcast:9 row_mask:0xf bank_mask:0xf
    v_dot2c_f32_bf16_dpp v21, v8, v118 row_newbcast:9 row_mask:0xf bank_mask:0xf
    v_dot2c_f32_bf16_dpp v22, v6, v119 row_newbcast:9 row_mask:0xf bank_mask:0xf
    v_dot2c_f32_bf16_dpp v23, v8, v119 row_newbcast:9 row_mask:0xf bank_mask:0xf
    s_waitcnt vmcnt(5)
    s_mov_b32 s11, 193536
    buffer_load_dwordx2 v[34:35], v5, s[64:67], s11 offen nt
    v_dot2c_f32_bf16_dpp v16, v6, v120 row_newbcast:10 row_mask:0xf bank_mask:0xf
    v_dot2c_f32_bf16_dpp v17, v8, v120 row_newbcast:10 row_mask:0xf bank_mask:0xf
    v_dot2c_f32_bf16_dpp v18, v6, v121 row_newbcast:10 row_mask:0xf bank_mask:0xf
    v_dot2c_f32_bf16_dpp v19, v8, v121 row_newbcast:10 row_mask:0xf bank_mask:0xf
    v_dot2c_f32_bf16_dpp v20, v6, v122 row_newbcast:10 row_mask:0xf bank_mask:0xf
    v_dot2c_f32_bf16_dpp v21, v8, v122 row_newbcast:10 row_mask:0xf bank_mask:0xf
    v_dot2c_f32_bf16_dpp v22, v6, v123 row_newbcast:10 row_mask:0xf bank_mask:0xf
    v_dot2c_f32_bf16_dpp v23, v8, v123 row_newbcast:10 row_mask:0xf bank_mask:0xf
    v_dot2c_f32_bf16_dpp v16, v6, v124 row_newbcast:11 row_mask:0xf bank_mask:0xf
    v_dot2c_f32_bf16_dpp v17, v8, v124 row_newbcast:11 row_mask:0xf bank_mask:0xf
    v_dot2c_f32_bf16_dpp v18, v6, v125 row_newbcast:11 row_mask:0xf bank_mask:0xf
    v_dot2c_f32_bf16_dpp v19, v8, v125 row_newbcast:11 row_mask:0xf bank_mask:0xf
    v_dot2c_f32_bf16_dpp v20, v6, v126 row_newbcast:11 row_mask:0xf bank_mask:0xf
    v_dot2c_f32_bf16_dpp v21, v8, v126 row_newbcast:11 row_mask:0xf bank_mask:0xf
    v_dot2c_f32_bf16_dpp v22, v6, v127 row_newbcast:11 row_mask:0xf bank_mask:0xf
    v_dot2c_f32_bf16_dpp v23, v8, v127 row_newbcast:11 row_mask:0xf bank_mask:0xf
    s_waitcnt vmcnt(5)
    s_mov_b32 s11, 202752
    buffer_load_dwordx2 v[36:37], v5, s[64:67], s11 offen nt
    v_dot2c_f32_bf16_dpp v16, v6, v128 row_newbcast:12 row_mask:0xf bank_mask:0xf
    v_dot2c_f32_bf16_dpp v17, v8, v128 row_newbcast:12 row_mask:0xf bank_mask:0xf
    v_dot2c_f32_bf16_dpp v18, v6, v129 row_newbcast:12 row_mask:0xf bank_mask:0xf
    v_dot2c_f32_bf16_dpp v19, v8, v129 row_newbcast:12 row_mask:0xf bank_mask:0xf
    v_dot2c_f32_bf16_dpp v20, v6, v130 row_newbcast:12 row_mask:0xf bank_mask:0xf
    v_dot2c_f32_bf16_dpp v21, v8, v130 row_newbcast:12 row_mask:0xf bank_mask:0xf
    v_dot2c_f32_bf16_dpp v22, v6, v131 row_newbcast:12 row_mask:0xf bank_mask:0xf
    v_dot2c_f32_bf16_dpp v23, v8, v131 row_newbcast:12 row_mask:0xf bank_mask:0xf
    v_dot2c_f32_bf16_dpp v16, v6, v132 row_newbcast:13 row_mask:0xf bank_mask:0xf
    v_dot2c_f32_bf16_dpp v17, v8, v132 row_newbcast:13 row_mask:0xf bank_mask:0xf
    v_dot2c_f32_bf16_dpp v18, v6, v133 row_newbcast:13 row_mask:0xf bank_mask:0xf
    v_dot2c_f32_bf16_dpp v19, v8, v133 row_newbcast:13 row_mask:0xf bank_mask:0xf
    v_dot2c_f32_bf16_dpp v20, v6, v134 row_newbcast:13 row_mask:0xf bank_mask:0xf
    v_dot2c_f32_bf16_dpp v21, v8, v134 row_newbcast:13 row_mask:0xf bank_mask:0xf
    v_dot2c_f32_bf16_dpp v22, v6, v135 row_newbcast:13 row_mask:0xf bank_mask:0xf
    v_dot2c_f32_bf16_dpp v23, v8, v135 row_newbcast:13 row_mask:0xf bank_mask:0xf
    s_waitcnt vmcnt(5)
    s_mov_b32 s11, 211968
    buffer_load_dwordx2 v[38:39], v5, s[64:67], s11 offen nt
    s_waitcnt vmcnt(5)
    s_mov_b32 s11, 221184
    buffer_load_dwordx2 v[40:41], v5, s[64:67], s11 offen nt
    s_waitcnt vmcnt(5)
    s_mov_b32 s11, 230400
    buffer_load_dwordx2 v[42:43], v5, s[64:67], s11 offen nt
    s_waitcnt vmcnt(5)
    s_mov_b32 s11, 239616
    buffer_load_dwordx2 v[44:45], v5, s[64:67], s11 offen nt
    s_waitcnt vmcnt(5)
    s_mov_b32 s11, 248832
    buffer_load_dwordx2 v[46:47], v5, s[64:67], s11 offen nt
    s_waitcnt vmcnt(5)
    s_mov_b32 s11, 258048
    buffer_load_dwordx2 v[48:49], v5, s[64:67], s11 offen nt
    s_waitcnt vmcnt(5)
    s_mov_b32 s11, 267264
    buffer_load_dwordx2 v[50:51], v5, s[64:67], s11 offen nt
    s_waitcnt vmcnt(5)
    s_mov_b32 s11, 276480
    buffer_load_dwordx2 v[52:53], v5, s[64:67], s11 offen nt
    s_waitcnt vmcnt(5)
    s_mov_b32 s11, 285696
    buffer_load_dwordx2 v[54:55], v5, s[64:67], s11 offen nt
    s_waitcnt vmcnt(5)
    s_mov_b32 s11, 294912
    buffer_load_dwordx2 v[56:57], v5, s[64:67], s11 offen nt
    s_waitcnt vmcnt(5)
    s_mov_b32 s11, 304128
    buffer_load_dwordx2 v[58:59], v5, s[64:67], s11 offen nt
    s_waitcnt vmcnt(5)
    s_mov_b32 s11, 313344
    buffer_load_dwordx2 v[60:61], v5, s[64:67], s11 offen nt
    s_waitcnt vmcnt(5)
    s_mov_b32 s11, 322560
    buffer_load_dwordx2 v[62:63], v5, s[64:67], s11 offen nt
    v_lshrrev_b32 v14, 5, v1
    v_mul_u32_u24 v14, 4608, v14
    v_and_b32 v6, 31, v1
    v_lshl_add_u32 v15, v6, 2, v14
    v_add_u32 v15, 1024, v15
    v_lshl_add_u32 v14, v6, 4, v14
    s_waitcnt vmcnt(5)
    buffer_load_dwordx4 v[68:71], v14, s[60:63], 0 offen offset:0 nt
    s_waitcnt vmcnt(5)
    buffer_load_dwordx4 v[72:75], v14, s[60:63], 0 offen offset:512 nt
    buffer_load_dword v64, v15, s[60:63], 0 offen offset:0 nt
    s_waitcnt vmcnt(5)
    buffer_load_dwordx4 v[76:79], v14, s[60:63], 0 offen offset:1152 nt
    s_waitcnt vmcnt(5)
    buffer_load_dwordx4 v[80:83], v14, s[60:63], 0 offen offset:1664 nt
    buffer_load_dword v65, v15, s[60:63], 0 offen offset:1152 nt
    s_waitcnt vmcnt(5)
    buffer_load_dwordx4 v[84:87], v14, s[60:63], 0 offen offset:2304 nt
    s_waitcnt vmcnt(5)
    buffer_load_dwordx4 v[88:91], v14, s[60:63], 0 offen offset:2816 nt
    buffer_load_dword v66, v15, s[60:63], 0 offen offset:2304 nt
    s_waitcnt vmcnt(5)
    buffer_load_dwordx4 v[92:95], v14, s[60:63], 0 offen offset:3456 nt
    s_waitcnt vmcnt(5)
    buffer_load_dwordx4 v[96:99], v14, s[60:63], 0 offen offset:3968 nt
    buffer_load_dword v67, v15, s[60:63], 0 offen offset:3456 nt
    s_waitcnt vmcnt(1)
    v_mov_b32 v0, 2
    s_mov_b64 exec, 1
    buffer_atomic_add v0, v10, s[48:51], s68 offen sc0 sc1
    s_mov_b64 exec, -1
    s_add_u32 s52, s18, s47
    s_addc_u32 s53, s19, 0
    s_lshl_b32 s54, s69, 10
    s_add_u32 s56, s20, s47
    s_addc_u32 s57, s21, 0
    s_mov_b32 s58, s54
    s_waitcnt vmcnt(0)
    v_readfirstlane_b32 s70, v0
    s_nop 0
    s_min_u32 s70, s70, s69
    s_lshl_b32 s11, s70, 10
    buffer_load_dwordx4 v[100:103], v4, s[52:55], s11 offen offset:0 nt
    buffer_load_dwordx4 v[104:107], v4, s[52:55], s11 offen offset:1024 nt
    buffer_load_dwordx4 v[108:111], v4, s[56:59], s11 offen offset:0 nt
    buffer_load_dwordx4 v[112:115], v4, s[56:59], s11 offen offset:1024 nt
    v_mov_b32 v0, 2
    s_mov_b64 exec, 1
    buffer_atomic_add v0, v10, s[48:51], s68 offen sc0 sc1
    s_mov_b64 exec, -1
    v_and_b32 v14, 15, v1
    v_lshlrev_b32 v14, 4, v14
    ds_read_b128 v[132:135], v14 offset:64
    s_waitcnt lgkmcnt(0)
    s_nop 0
L_dyn_11:
    s_cmp_ge_u32 s70, s69
    s_cbranch_scc1 L_dynd_12
    s_waitcnt vmcnt(0)
    v_readfirstlane_b32 s71, v0
    s_nop 0
    s_cmp_ge_u32 s71, s69
    s_nop 1
    s_cbranch_scc1 L_dyns_13
    s_lshl_b32 s11, s71, 10
    buffer_load_dwordx4 v[116:119], v4, s[52:55], s11 offen offset:0 nt
    buffer_load_dwordx4 v[120:123], v4, s[52:55], s11 offen offset:1024 nt
    buffer_load_dwordx4 v[124:127], v4, s[56:59], s11 offen offset:0 nt
    buffer_load_dwordx4 v[128:131], v4, s[56:59], s11 offen offset:1024 nt
    v_mov_b32 v0, 2
    s_mov_b64 exec, 1
    buffer_atomic_add v0, v10, s[48:51], s68 offen sc0 sc1
    s_mov_b64 exec, -1
L_dyns_13:
    v_dot2_f32_bf16 v100, v100, v132, 0
    v_dot2_f32_bf16 v104, v104, v132, 0
    v_dot2_f32_bf16 v100, v101, v133, v100
    v_dot2_f32_bf16 v104, v105, v133, v104
    v_dot2_f32_bf16 v100, v102, v134, v100
    v_dot2_f32_bf16 v104, v106, v134, v104
    v_dot2_f32_bf16 v100, v103, v135, v100
    v_dot2_f32_bf16 v104, v107, v135, v104
    s_nop 1
    v_add_f32_dpp v100, v100, v100 row_ror:8 row_mask:0xf bank_mask:0xf
    v_add_f32_dpp v104, v104, v104 row_ror:8 row_mask:0xf bank_mask:0xf
    s_nop 0
    v_add_f32_dpp v100, v100, v100 row_ror:4 row_mask:0xf bank_mask:0xf
    v_add_f32_dpp v104, v104, v104 row_ror:4 row_mask:0xf bank_mask:0xf
    s_nop 0
    v_add_f32_dpp v100, v100, v100 row_ror:2 row_mask:0xf bank_mask:0xf
    v_add_f32_dpp v104, v104, v104 row_ror:2 row_mask:0xf bank_mask:0xf
    s_nop 0
    v_add_f32_dpp v100, v100, v100 row_ror:1 row_mask:0xf bank_mask:0xf
    v_add_f32_dpp v104, v104, v104 row_ror:1 row_mask:0xf bank_mask:0xf
    v_cvt_pk_bf16_f32 v14, v100, v104
    v_lshlrev_b32 v100, 16, v14
    v_and_b32 v104, s78, v14
    v_mul_f32 v100, 0x3db504f3, v100
    v_mul_f32 v104, 0x3db504f3, v104
    v_cvt_pk_bf16_f32 v14, v100, v104
    v_lshlrev_b32 v100, 16, v14
    v_and_b32 v104, s78, v14
    v_max3_f32 v14, v100, v104, v12
    v_mov_b32 v15, v14
    s_nop 1
    v_permlane16_swap_b32 v14, v15
    v_max_f32 v14, v14, v15
    v_mov_b32 v15, v14
    s_nop 1
    v_permlane32_swap_b32 v14, v15
    v_max_f32 v14, v14, v15
    v_sub_f32 v15, v12, v14
    v_sub_f32 v100, v100, v14
    v_sub_f32 v104, v104, v14
    v_mul_f32 v15, 0x3fb8aa3b, v15
    v_mul_f32 v100, 0x3fb8aa3b, v100
    v_mul_f32 v104, 0x3fb8aa3b, v104
    v_mov_b32 v12, v14
    v_exp_f32 v14, v15
    v_exp_f32 v100, v100
    v_exp_f32 v104, v104
    v_pk_mul_f32 v[16:17], v[16:17], v[14:15] op_sel_hi:[1,0]
    v_pk_mul_f32 v[18:19], v[18:19], v[14:15] op_sel_hi:[1,0]
    v_pk_mul_f32 v[20:21], v[20:21], v[14:15] op_sel_hi:[1,0]
    v_pk_mul_f32 v[22:23], v[22:23], v[14:15] op_sel_hi:[1,0]
    v_fma_f32 v13, v13, v14, v100
    v_add_f32 v13, v13, v104
    v_cvt_pk_bf16_f32 v101, 0, v100
    v_cvt_pk_bf16_f32 v100, v100, 0
    v_cvt_pk_bf16_f32 v105, 0, v104
    v_cvt_pk_bf16_f32 v104, v104, 0
    v_dot2c_f32_bf16 v16, v100, v108
    v_dot2c_f32_bf16 v17, v101, v108
    v_dot2c_f32_bf16 v18, v100, v109
    v_dot2c_f32_bf16 v19, v101, v109
    v_dot2c_f32_bf16 v20, v100, v110
    v_dot2c_f32_bf16 v21, v101, v110
    v_dot2c_f32_bf16 v22, v100, v111
    v_dot2c_f32_bf16 v23, v101, v111
    v_dot2c_f32_bf16 v16, v104, v112
    v_dot2c_f32_bf16 v17, v105, v112
    v_dot2c_f32_bf16 v18, v104, v113
    v_dot2c_f32_bf16 v19, v105, v113
    v_dot2c_f32_bf16 v20, v104, v114
    v_dot2c_f32_bf16 v21, v105, v114
    v_dot2c_f32_bf16 v22, v104, v115
    v_dot2c_f32_bf16 v23, v105, v115
    s_cmp_ge_u32 s71, s69
    s_nop 0
    s_cbranch_scc1 L_dynd_12
    s_waitcnt vmcnt(0)
    v_readfirstlane_b32 s70, v0
    s_nop 0
    s_cmp_ge_u32 s70, s69
    s_nop 1
    s_cbranch_scc1 L_dyns_14
    s_lshl_b32 s11, s70, 10
    buffer_load_dwordx4 v[100:103], v4, s[52:55], s11 offen offset:0 nt
    buffer_load_dwordx4 v[104:107], v4, s[52:55], s11 offen offset:1024 nt
    buffer_load_dwordx4 v[108:111], v4, s[56:59], s11 offen offset:0 nt
    buffer_load_dwordx4 v[112:115], v4, s[56:59], s11 offen offset:1024 nt
    v_mov_b32 v0, 2
    s_mov_b64 exec, 1
    buffer_atomic_add v0, v10, s[48:51], s68 offen sc0 sc1
    s_mov_b64 exec, -1
L_dyns_14:
    v_dot2_f32_bf16 v116, v116, v132, 0
    v_dot2_f32_bf16 v120, v120, v132, 0
    v_dot2_f32_bf16 v116, v117, v133, v116
    v_dot2_f32_bf16 v120, v121, v133, v120
    v_dot2_f32_bf16 v116, v118, v134, v116
    v_dot2_f32_bf16 v120, v122, v134, v120
    v_dot2_f32_bf16 v116, v119, v135, v116
    v_dot2_f32_bf16 v120, v123, v135, v120
    s_nop 1
    v_add_f32_dpp v116, v116, v116 row_ror:8 row_mask:0xf bank_mask:0xf
    v_add_f32_dpp v120, v120, v120 row_ror:8 row_mask:0xf bank_mask:0xf
    s_nop 0
    v_add_f32_dpp v116, v116, v116 row_ror:4 row_mask:0xf bank_mask:0xf
    v_add_f32_dpp v120, v120, v120 row_ror:4 row_mask:0xf bank_mask:0xf
    s_nop 0
    v_add_f32_dpp v116, v116, v116 row_ror:2 row_mask:0xf bank_mask:0xf
    v_add_f32_dpp v120, v120, v120 row_ror:2 row_mask:0xf bank_mask:0xf
    s_nop 0
    v_add_f32_dpp v116, v116, v116 row_ror:1 row_mask:0xf bank_mask:0xf
    v_add_f32_dpp v120, v120, v120 row_ror:1 row_mask:0xf bank_mask:0xf
    v_cvt_pk_bf16_f32 v14, v116, v120
    v_lshlrev_b32 v116, 16, v14
    v_and_b32 v120, s78, v14
    v_mul_f32 v116, 0x3db504f3, v116
    v_mul_f32 v120, 0x3db504f3, v120
    v_cvt_pk_bf16_f32 v14, v116, v120
    v_lshlrev_b32 v116, 16, v14
    v_and_b32 v120, s78, v14
    v_max3_f32 v14, v116, v120, v12
    v_mov_b32 v15, v14
    s_nop 1
    v_permlane16_swap_b32 v14, v15
    v_max_f32 v14, v14, v15
    v_mov_b32 v15, v14
    s_nop 1
    v_permlane32_swap_b32 v14, v15
    v_max_f32 v14, v14, v15
    v_sub_f32 v15, v12, v14
    v_sub_f32 v116, v116, v14
    v_sub_f32 v120, v120, v14
    v_mul_f32 v15, 0x3fb8aa3b, v15
    v_mul_f32 v116, 0x3fb8aa3b, v116
    v_mul_f32 v120, 0x3fb8aa3b, v120
    v_mov_b32 v12, v14
    v_exp_f32 v14, v15
    v_exp_f32 v116, v116
    v_exp_f32 v120, v120
    v_pk_mul_f32 v[16:17], v[16:17], v[14:15] op_sel_hi:[1,0]
    v_pk_mul_f32 v[18:19], v[18:19], v[14:15] op_sel_hi:[1,0]
    v_pk_mul_f32 v[20:21], v[20:21], v[14:15] op_sel_hi:[1,0]
    v_pk_mul_f32 v[22:23], v[22:23], v[14:15] op_sel_hi:[1,0]
    v_fma_f32 v13, v13, v14, v116
    v_add_f32 v13, v13, v120
    v_cvt_pk_bf16_f32 v117, 0, v116
    v_cvt_pk_bf16_f32 v116, v116, 0
    v_cvt_pk_bf16_f32 v121, 0, v120
    v_cvt_pk_bf16_f32 v120, v120, 0
    v_dot2c_f32_bf16 v16, v116, v124
    v_dot2c_f32_bf16 v17, v117, v124
    v_dot2c_f32_bf16 v18, v116, v125
    v_dot2c_f32_bf16 v19, v117, v125
    v_dot2c_f32_bf16 v20, v116, v126
    v_dot2c_f32_bf16 v21, v117, v126
    v_dot2c_f32_bf16 v22, v116, v127
    v_dot2c_f32_bf16 v23, v117, v127
    v_dot2c_f32_bf16 v16, v120, v128
    v_dot2c_f32_bf16 v17, v121, v128
    v_dot2c_f32_bf16 v18, v120, v129
    v_dot2c_f32_bf16 v19, v121, v129
    v_dot2c_f32_bf16 v20, v120, v130
    v_dot2c_f32_bf16 v21, v121, v130
    v_dot2c_f32_bf16 v22, v120, v131
    v_dot2c_f32_bf16 v23, v121, v131
    s_nop 1
    s_branch L_dyn_11
L_dynd_12:
    s_waitcnt vmcnt(1)
    v_mov_b32 v15, v13
    s_nop 1
    v_permlane16_swap_b32 v13, v15
    v_add_f32 v13, v13, v15
    v_mov_b32 v15, v13
    s_nop 1
    v_permlane32_swap_b32 v13, v15
    v_add_f32 v13, v13, v15
    v_permlane32_swap_b32 v16, v20
    v_permlane32_swap_b32 v17, v21
    v_permlane32_swap_b32 v18, v22
    v_permlane32_swap_b32 v19, v23
    v_add_f32 v16, v16, v20
    v_add_f32 v17, v17, v21
    v_add_f32 v18, v18, v22
    v_add_f32 v19, v19, v23
    s_nop 0
    v_permlane16_swap_b32 v16, v18
    v_permlane16_swap_b32 v17, v19
    v_add_f32 v16, v16, v18
    v_add_f32 v17, v17, v19
    s_lshl_b32 s13, s3, 3
    v_mov_b32 v14, s13
    ds_write_b64 v3, v[16:17] offset:1024
    s_mov_b64 exec, 1
    ds_write_b64 v14, v[12:13] offset:320
    ds_add_rtn_u32 v12, v10, v11 offset:12
    s_mov_b32 exec_lo, -1
    v_and_b32 v14, 7, v1
    v_lshlrev_b32 v14, 3, v14
    s_waitcnt lgkmcnt(0)
    v_readfirstlane_b32 s12, v12
    s_nop 0
    s_cmp_lg_u32 s12, 7
    s_nop 1
    s_cbranch_scc1 L_oxd_15
    ds_read_b64 v[12:13], v14 offset:320
    ds_read_b128 v[100:103], v4 offset:1024
    ds_read_b128 v[104:107], v4 offset:1536
    ds_read_b128 v[108:111], v4 offset:2048
    ds_read_b128 v[112:115], v4 offset:2560
    ds_read_b128 v[116:119], v4 offset:3072
    ds_read_b128 v[120:123], v4 offset:3584
    ds_read_b128 v[124:127], v4 offset:4096
    ds_read_b128 v[128:131], v4 offset:4608
    s_waitcnt lgkmcnt(8)
    v_max_f32_dpp v14, v12, v12 quad_perm:[1,0,3,2] row_mask:0xf bank_mask:0xf
    s_nop 1
    v_max_f32_dpp v14, v14, v14 quad_perm:[2,3,0,1] row_mask:0xf bank_mask:0xf
    s_nop 1
    v_max_f32_dpp v14, v14, v14 row_half_mirror row_mask:0xf bank_mask:0xf
    v_sub_f32 v12, v12, v14
    v_mul_f32 v12, 0x3fb8aa3b, v12
    v_exp_f32 v12, v12
    s_lshl_b32 s13, s8, 4
    s_add_u32 s13, s13, 0x50000
    v_mul_f32 v15, v13, v12
    v_min_u32 v14, -2, v14
    s_nop 0
    v_add_f32_dpp v15, v15, v15 quad_perm:[1,0,3,2] row_mask:0xf bank_mask:0xf
    s_nop 1
    v_add_f32_dpp v15, v15, v15 quad_perm:[2,3,0,1] row_mask:0xf bank_mask:0xf
    s_nop 1
    v_add_f32_dpp v15, v15, v15 row_half_mirror row_mask:0xf bank_mask:0xf
    v_min_u32 v15, -2, v15
    s_mov_b64 exec, 1
    buffer_store_dwordx2 v[14:15], v10, s[48:51], s13 offen sc1
    s_mov_b32 exec_lo, -1
    s_waitcnt lgkmcnt(6)
    v_mul_f32_dpp v16, v12, v100 row_newbcast:0 row_mask:0xf bank_mask:0xf
    v_mul_f32_dpp v17, v12, v101 row_newbcast:0 row_mask:0xf bank_mask:0xf
    v_mul_f32_dpp v18, v12, v102 row_newbcast:0 row_mask:0xf bank_mask:0xf
    v_mul_f32_dpp v19, v12, v103 row_newbcast:0 row_mask:0xf bank_mask:0xf
    v_fmac_f32_dpp v16, v12, v104 row_newbcast:1 row_mask:0xf bank_mask:0xf
    v_fmac_f32_dpp v17, v12, v105 row_newbcast:1 row_mask:0xf bank_mask:0xf
    v_fmac_f32_dpp v18, v12, v106 row_newbcast:1 row_mask:0xf bank_mask:0xf
    v_fmac_f32_dpp v19, v12, v107 row_newbcast:1 row_mask:0xf bank_mask:0xf
    s_waitcnt lgkmcnt(4)
    v_fmac_f32_dpp v16, v12, v108 row_newbcast:2 row_mask:0xf bank_mask:0xf
    v_fmac_f32_dpp v17, v12, v109 row_newbcast:2 row_mask:0xf bank_mask:0xf
    v_fmac_f32_dpp v18, v12, v110 row_newbcast:2 row_mask:0xf bank_mask:0xf
    v_fmac_f32_dpp v19, v12, v111 row_newbcast:2 row_mask:0xf bank_mask:0xf
    v_fmac_f32_dpp v16, v12, v112 row_newbcast:3 row_mask:0xf bank_mask:0xf
    v_fmac_f32_dpp v17, v12, v113 row_newbcast:3 row_mask:0xf bank_mask:0xf
    v_fmac_f32_dpp v18, v12, v114 row_newbcast:3 row_mask:0xf bank_mask:0xf
    v_fmac_f32_dpp v19, v12, v115 row_newbcast:3 row_mask:0xf bank_mask:0xf
    s_waitcnt lgkmcnt(2)
    v_fmac_f32_dpp v16, v12, v116 row_newbcast:4 row_mask:0xf bank_mask:0xf
    v_fmac_f32_dpp v17, v12, v117 row_newbcast:4 row_mask:0xf bank_mask:0xf
    v_fmac_f32_dpp v18, v12, v118 row_newbcast:4 row_mask:0xf bank_mask:0xf
    v_fmac_f32_dpp v19, v12, v119 row_newbcast:4 row_mask:0xf bank_mask:0xf
    v_fmac_f32_dpp v16, v12, v120 row_newbcast:5 row_mask:0xf bank_mask:0xf
    v_fmac_f32_dpp v17, v12, v121 row_newbcast:5 row_mask:0xf bank_mask:0xf
    v_fmac_f32_dpp v18, v12, v122 row_newbcast:5 row_mask:0xf bank_mask:0xf
    v_fmac_f32_dpp v19, v12, v123 row_newbcast:5 row_mask:0xf bank_mask:0xf
    s_waitcnt lgkmcnt(0)
    v_fmac_f32_dpp v16, v12, v124 row_newbcast:6 row_mask:0xf bank_mask:0xf
    v_fmac_f32_dpp v17, v12, v125 row_newbcast:6 row_mask:0xf bank_mask:0xf
    v_fmac_f32_dpp v18, v12, v126 row_newbcast:6 row_mask:0xf bank_mask:0xf
    v_fmac_f32_dpp v19, v12, v127 row_newbcast:6 row_mask:0xf bank_mask:0xf
    v_fmac_f32_dpp v16, v12, v128 row_newbcast:7 row_mask:0xf bank_mask:0xf
    v_fmac_f32_dpp v17, v12, v129 row_newbcast:7 row_mask:0xf bank_mask:0xf
    v_fmac_f32_dpp v18, v12, v130 row_newbcast:7 row_mask:0xf bank_mask:0xf
    v_fmac_f32_dpp v19, v12, v131 row_newbcast:7 row_mask:0xf bank_mask:0xf
    v_min_u32 v16, -2, v16
    v_min_u32 v17, -2, v17
    v_min_u32 v18, -2, v18
    v_min_u32 v19, -2, v19
    v_min_u32 v15, -2, v15
    buffer_store_dwordx4 v[16:19], v4, s[48:51], s15 offen sc1
    s_nop 1
L_oxd_15:
    s_mov_b64 exec, -1
    v_lshrrev_b32 v3, 4, v1
    v_mul_u32_u24 v3, 18, v3
    s_mul_i32 s12, s79, 72
    v_add_u32 v3, s12, v3
    v_and_b32 v7, 1, v1
    v_add3_u32 v7, v7, v3, 16
    v_and_b32 v12, 15, v1
    v_add_u32 v3, v3, v12
    v_lshrrev_b32 v12, 1, v3
    v_lshlrev_b32 v12, 4, v12
    v_lshrrev_b32 v13, 1, v7
    v_lshlrev_b32 v13, 4, v13
    s_mov_b32 s52, 0xa000
    s_mov_b32 s53, 0xb000
    s_mov_b32 s54, 0xc000
    s_mov_b32 s55, 0xf480
    s_mov_b32 s14, 400000
L_sbcb_16:
    buffer_load_dwordx4 v[100:103], v12, s[48:51], s53 offen sc1
    buffer_load_dwordx4 v[104:107], v12, s[48:51], s54 offen sc1
    buffer_load_dwordx4 v[108:111], v13, s[48:51], s53 offen sc1
    buffer_load_dwordx4 v[112:115], v13, s[48:51], s54 offen sc1
    s_waitcnt vmcnt(0)
    v_cmp_ne_u64 vcc, s[44:45], v[102:103]
    v_cmp_ne_u64 s[12:13], s[44:45], v[106:107]
    s_nop 0
    s_or_b64 vcc, vcc, s[12:13]
    v_cmp_ne_u64 s[12:13], s[44:45], v[110:111]
    s_nop 0
    s_or_b64 vcc, vcc, s[12:13]
    v_cmp_ne_u64 s[12:13], s[44:45], v[114:115]
    s_nop 0
    s_or_b64 vcc, vcc, s[12:13]
    s_cmp_eq_u64 vcc, 0
    s_nop 0
    s_cbranch_scc1 L_sbcbd_17
    s_sleep 4
    s_sub_u32 s14, s14, 1
    s_cbranch_scc0 L_sbcb_16
L_sbcbd_17:
    v_cndmask_b32 v100, v100, v101, s[74:75]
    v_cndmask_b32 v104, v104, v105, s[74:75]
    v_cndmask_b32 v108, v108, v109, s[74:75]
    v_cndmask_b32 v112, v112, v113, s[74:75]
    v_lshlrev_b32 v128, 16, v100
    v_and_b32 v129, s78, v100
    v_lshlrev_b32 v130, 16, v104
    v_and_b32 v131, s78, v104
    v_lshlrev_b32 v132, 16, v108
    v_and_b32 v133, s78, v108
    v_lshlrev_b32 v134, 16, v112
    v_and_b32 v135, s78, v112
    v_lshlrev_b32 v3, 3, v3
    v_lshlrev_b32 v9, 3, v7
    s_mul_i32 s12, s3, 48
    v_add_u32 v4, s12, v1
    v_lshlrev_b32 v5, 4, v4
    v_lshrrev_b32 v6, 2, v4
    s_mov_b32 s13, 4608
    v_mul_lo_u32 v6, s13, v6
    v_and_b32 v7, 3, v4
    v_lshl_add_u32 v6, v7, 4, v6
    s_lshl_b32 s12, s9, 6
    s_add_u32 s15, s12, 0x100000
    v_mov_b32 v7, v9
    v_lshlrev_b32 v8, 4, v1
    v_lshlrev_b32 v9, 2, v1
    v_and_b32 v12, 15, v1
    v_lshrrev_b32 v13, 4, v1
    v_lshl_add_u32 v12, v12, 2, v13
    v_lshlrev_b32 v12, 2, v12
    s_lshl_b32 s12, s3, 8
    v_add_u32 v12, s12, v12
    v_lshrrev_b32 v4, 5, v1
    v_and_b32 v13, 3, v1
    v_lshl_add_u32 v13, v4, 2, v13
    v_lshlrev_b32 v13, 2, v13
    s_lshl_b32 s12, s3, 5
    v_add_u32 v13, s12, v13
    v_and_b32 v14, 31, v1
    v_lshl_add_u32 v4, v14, 1, v4
    s_mul_i32 s12, s3, 2304
    v_lshlrev_b32 v14, 4, v4
    v_add_u32 v14, s12, v14
    v_lshlrev_b32 v15, 2, v4
    v_add_u32 v15, s12, v15
    v_perm_b32 v0, v138, v136, s76
    v_perm_b32 v138, v138, v136, s77
    v_perm_b32 v136, v139, v137, s76
    v_perm_b32 v139, v139, v137, s77
    v_perm_b32 v137, v142, v140, s76
    v_perm_b32 v142, v142, v140, s77
    v_perm_b32 v140, v143, v141, s76
    v_perm_b32 v143, v143, v141, s77
    v_perm_b32 v141, v146, v144, s76
    v_perm_b32 v146, v146, v144, s77
    v_perm_b32 v144, v147, v145, s76
    v_perm_b32 v147, v147, v145, s77
    v_perm_b32 v145, v150, v148, s76
    v_perm_b32 v150, v150, v148, s77
    v_perm_b32 v148, v151, v149, s76
    v_perm_b32 v151, v151, v149, s77
    v_perm_b32 v149, v154, v152, s76
    v_perm_b32 v154, v154, v152, s77
    v_perm_b32 v152, v155, v153, s76
    v_perm_b32 v155, v155, v153, s77
    v_perm_b32 v153, v158, v156, s76
    v_perm_b32 v158, v158, v156, s77
    v_perm_b32 v156, v159, v157, s76
    v_perm_b32 v159, v159, v157, s77
    v_perm_b32 v157, v162, v160, s76
    v_perm_b32 v162, v162, v160, s77
    v_perm_b32 v160, v163, v161, s76
    v_perm_b32 v163, v163, v161, s77
    v_perm_b32 v161, v166, v164, s76
    v_perm_b32 v166, v166, v164, s77
    v_perm_b32 v164, v167, v165, s76
    v_perm_b32 v167, v167, v165, s77
    v_perm_b32 v165, v26, v24, s76
    v_perm_b32 v26, v26, v24, s77
    v_perm_b32 v24, v27, v25, s76
    v_perm_b32 v27, v27, v25, s77
    v_perm_b32 v25, v30, v28, s76
    v_perm_b32 v30, v30, v28, s77
    v_perm_b32 v28, v31, v29, s76
    v_perm_b32 v31, v31, v29, s77
    v_perm_b32 v29, v34, v32, s76
    v_perm_b32 v34, v34, v32, s77
    v_perm_b32 v32, v35, v33, s76
    v_perm_b32 v35, v35, v33, s77
    v_perm_b32 v33, v38, v36, s76
    v_perm_b32 v38, v38, v36, s77
    v_perm_b32 v36, v39, v37, s76
    v_perm_b32 v39, v39, v37, s77
    v_perm_b32 v37, v42, v40, s76
    v_perm_b32 v42, v42, v40, s77
    v_perm_b32 v40, v43, v41, s76
    v_perm_b32 v43, v43, v41, s77
    v_perm_b32 v41, v46, v44, s76
    v_perm_b32 v46, v46, v44, s77
    v_perm_b32 v44, v47, v45, s76
    v_perm_b32 v47, v47, v45, s77
    v_perm_b32 v45, v50, v48, s76
    v_perm_b32 v50, v50, v48, s77
    v_perm_b32 v48, v51, v49, s76
    v_perm_b32 v51, v51, v49, s77
    v_perm_b32 v49, v54, v52, s76
    v_perm_b32 v54, v54, v52, s77
    v_perm_b32 v52, v55, v53, s76
    v_perm_b32 v55, v55, v53, s77
    v_perm_b32 v53, v58, v56, s76
    v_perm_b32 v58, v58, v56, s77
    v_perm_b32 v56, v59, v57, s76
    v_perm_b32 v59, v59, v57, s77
    v_perm_b32 v57, v62, v60, s76
    v_perm_b32 v62, v62, v60, s77
    v_perm_b32 v60, v63, v61, s76
    v_perm_b32 v63, v63, v61, s77
    v_perm_b32 v61, v76, v68, s76
    v_perm_b32 v76, v76, v68, s77
    v_perm_b32 v68, v77, v69, s76
    v_perm_b32 v77, v77, v69, s77
    v_perm_b32 v69, v78, v70, s76
    v_perm_b32 v78, v78, v70, s77
    v_perm_b32 v70, v79, v71, s76
    v_perm_b32 v79, v79, v71, s77
    v_perm_b32 v71, v80, v72, s76
    v_perm_b32 v80, v80, v72, s77
    v_perm_b32 v72, v81, v73, s76
    v_perm_b32 v81, v81, v73, s77
    v_perm_b32 v73, v82, v74, s76
    v_perm_b32 v82, v82, v74, s77
    v_perm_b32 v74, v83, v75, s76
    v_perm_b32 v83, v83, v75, s77
    v_perm_b32 v75, v65, v64, s76
    v_perm_b32 v65, v65, v64, s77
    v_perm_b32 v64, v92, v84, s76
    v_perm_b32 v92, v92, v84, s77
    v_perm_b32 v84, v93, v85, s76
    v_perm_b32 v93, v93, v85, s77
    v_perm_b32 v85, v94, v86, s76
    v_perm_b32 v94, v94, v86, s77
    v_perm_b32 v86, v95, v87, s76
    v_perm_b32 v95, v95, v87, s77
    v_perm_b32 v87, v96, v88, s76
    v_perm_b32 v96, v96, v88, s77
    v_perm_b32 v88, v97, v89, s76
    v_perm_b32 v97, v97, v89, s77
    v_perm_b32 v89, v98, v90, s76
    v_perm_b32 v98, v98, v90, s77
    v_perm_b32 v90, v99, v91, s76
    v_perm_b32 v99, v99, v91, s77
    v_perm_b32 v91, v67, v66, s76
    v_perm_b32 v67, v67, v66, s77
    v_mov_b32 v16, 0
    v_mov_b32 v17, 0
    v_mov_b32 v18, 0
    v_mov_b32 v19, 0
    s_barrier
    ds_read_b128 v[100:103], v8 offset:5120
    ds_read_b128 v[104:107], v8 offset:6144
    ds_read_b32 v20, v9 offset:7168
    ds_read_b64 v[108:109], v3 offset:5120
    ds_read_b64 v[110:111], v7 offset:5120
    s_waitcnt lgkmcnt(2)
    v_mul_f32 v113, v100, v100
    v_add_f32 v112, v100, v101
    v_fmac_f32 v113, v101, v101
    v_add_f32 v112, v112, v102
    v_fmac_f32 v113, v102, v102
    v_add_f32 v112, v112, v103
    v_fmac_f32 v113, v103, v103
    v_add_f32 v112, v112, v104
    v_fmac_f32 v113, v104, v104
    v_add_f32 v112, v112, v105
    v_fmac_f32 v113, v105, v105
    v_add_f32 v112, v112, v106
    v_fmac_f32 v113, v106, v106
    v_add_f32 v112, v112, v107
    v_fmac_f32 v113, v107, v107
    v_add_f32 v112, v112, v20
    v_fmac_f32 v113, v20, v20
    s_nop 0
    v_add_f32_dpp v112, v112, v112 row_ror:8 row_mask:0xf bank_mask:0xf
    v_add_f32_dpp v113, v113, v113 row_ror:8 row_mask:0xf bank_mask:0xf
    s_nop 0
    v_add_f32_dpp v112, v112, v112 row_ror:4 row_mask:0xf bank_mask:0xf
    v_add_f32_dpp v113, v113, v113 row_ror:4 row_mask:0xf bank_mask:0xf
    s_nop 0
    v_add_f32_dpp v112, v112, v112 row_ror:2 row_mask:0xf bank_mask:0xf
    v_add_f32_dpp v113, v113, v113 row_ror:2 row_mask:0xf bank_mask:0xf
    s_nop 0
    v_add_f32_dpp v112, v112, v112 row_ror:1 row_mask:0xf bank_mask:0xf
    v_add_f32_dpp v113, v113, v113 row_ror:1 row_mask:0xf bank_mask:0xf
    v_mov_b32 v114, v112
    v_mov_b32 v115, v113
    s_nop 0
    v_permlane16_swap_b32 v112, v114
    v_permlane16_swap_b32 v113, v115
    v_add_f32 v112, v112, v114
    v_add_f32 v113, v113, v115
    v_mov_b32 v114, v112
    v_mov_b32 v115, v113
    s_nop 0
    v_permlane32_swap_b32 v112, v114
    v_permlane32_swap_b32 v113, v115
    v_add_f32 v112, v112, v114
    v_add_f32 v113, v113, v115
    v_mul_f32 v112, 0x3ae38e39, v112
    v_mul_f32 v113, 0x3ae38e39, v113
    v_fma_f32 v113, -v112, v112, v113
    v_max_f32 v113, 0, v113
    v_cvt_pk_bf16_f32 v114, v112, v113
    v_lshlrev_b32 v112, 16, v114
    v_and_b32 v113, s78, v114
    v_add_f32 v113, 0x3727c5ac, v113
    v_cvt_pk_bf16_f32 v113, v113, v113
    v_and_b32 v113, s78, v113
    v_sqrt_f32 v113, v113
    s_nop 0
    v_cvt_pk_bf16_f32 v113, v113, v113
    v_and_b32 v113, s78, v113
    v_rcp_f32 v113, v113
    s_waitcnt lgkmcnt(0)
    v_sub_f32 v108, v108, v112
    v_sub_f32 v109, v109, v112
    v_sub_f32 v110, v110, v112
    v_sub_f32 v111, v111, v112
    v_cvt_pk_bf16_f32 v20, v108, v109
    v_lshlrev_b32 v108, 16, v20
    v_and_b32 v109, s78, v20
    v_cvt_pk_bf16_f32 v21, v110, v111
    v_lshlrev_b32 v110, 16, v21
    v_and_b32 v111, s78, v21
    v_mul_f32 v108, v108, v113
    v_mul_f32 v109, v109, v113
    v_mul_f32 v110, v110, v113
    v_mul_f32 v111, v111, v113
    v_cvt_pk_bf16_f32 v20, v108, v109
    v_lshlrev_b32 v108, 16, v20
    v_and_b32 v109, s78, v20
    v_cvt_pk_bf16_f32 v21, v110, v111
    v_lshlrev_b32 v110, 16, v21
    v_and_b32 v111, s78, v21
    v_mul_f32 v108, v108, v130
    v_mul_f32 v109, v109, v131
    v_mul_f32 v110, v110, v134
    v_mul_f32 v111, v111, v135
    v_cvt_pk_bf16_f32 v20, v108, v109
    v_lshlrev_b32 v108, 16, v20
    v_and_b32 v109, s78, v20
    v_cvt_pk_bf16_f32 v21, v110, v111
    v_lshlrev_b32 v110, 16, v21
    v_and_b32 v111, s78, v21
    v_add_f32 v108, v108, v128
    v_add_f32 v109, v109, v129
    v_add_f32 v110, v110, v132
    v_add_f32 v111, v111, v133
    v_cvt_pk_bf16_f32 v20, v108, v109
    v_cvt_pk_bf16_f32 v21, v110, v111
    s_nop 0
    v_dot2c_f32_bf16_dpp v16, v20, v0 row_newbcast:0 row_mask:0xf bank_mask:0xf
    v_dot2c_f32_bf16_dpp v17, v20, v138 row_newbcast:0 row_mask:0xf bank_mask:0xf
    v_dot2c_f32_bf16_dpp v18, v20, v136 row_newbcast:0 row_mask:0xf bank_mask:0xf
    v_dot2c_f32_bf16_dpp v19, v20, v139 row_newbcast:0 row_mask:0xf bank_mask:0xf
    v_dot2c_f32_bf16_dpp v16, v20, v137 row_newbcast:1 row_mask:0xf bank_mask:0xf
    v_dot2c_f32_bf16_dpp v17, v20, v142 row_newbcast:1 row_mask:0xf bank_mask:0xf
    v_dot2c_f32_bf16_dpp v18, v20, v140 row_newbcast:1 row_mask:0xf bank_mask:0xf
    v_dot2c_f32_bf16_dpp v19, v20, v143 row_newbcast:1 row_mask:0xf bank_mask:0xf
    v_dot2c_f32_bf16_dpp v16, v20, v141 row_newbcast:2 row_mask:0xf bank_mask:0xf
    v_dot2c_f32_bf16_dpp v17, v20, v146 row_newbcast:2 row_mask:0xf bank_mask:0xf
    v_dot2c_f32_bf16_dpp v18, v20, v144 row_newbcast:2 row_mask:0xf bank_mask:0xf
    v_dot2c_f32_bf16_dpp v19, v20, v147 row_newbcast:2 row_mask:0xf bank_mask:0xf
    v_dot2c_f32_bf16_dpp v16, v20, v145 row_newbcast:3 row_mask:0xf bank_mask:0xf
    v_dot2c_f32_bf16_dpp v17, v20, v150 row_newbcast:3 row_mask:0xf bank_mask:0xf
    v_dot2c_f32_bf16_dpp v18, v20, v148 row_newbcast:3 row_mask:0xf bank_mask:0xf
    v_dot2c_f32_bf16_dpp v19, v20, v151 row_newbcast:3 row_mask:0xf bank_mask:0xf
    v_dot2c_f32_bf16_dpp v16, v20, v149 row_newbcast:4 row_mask:0xf bank_mask:0xf
    v_dot2c_f32_bf16_dpp v17, v20, v154 row_newbcast:4 row_mask:0xf bank_mask:0xf
    v_dot2c_f32_bf16_dpp v18, v20, v152 row_newbcast:4 row_mask:0xf bank_mask:0xf
    v_dot2c_f32_bf16_dpp v19, v20, v155 row_newbcast:4 row_mask:0xf bank_mask:0xf
    v_dot2c_f32_bf16_dpp v16, v20, v153 row_newbcast:5 row_mask:0xf bank_mask:0xf
    v_dot2c_f32_bf16_dpp v17, v20, v158 row_newbcast:5 row_mask:0xf bank_mask:0xf
    v_dot2c_f32_bf16_dpp v18, v20, v156 row_newbcast:5 row_mask:0xf bank_mask:0xf
    v_dot2c_f32_bf16_dpp v19, v20, v159 row_newbcast:5 row_mask:0xf bank_mask:0xf
    v_dot2c_f32_bf16_dpp v16, v20, v157 row_newbcast:6 row_mask:0xf bank_mask:0xf
    v_dot2c_f32_bf16_dpp v17, v20, v162 row_newbcast:6 row_mask:0xf bank_mask:0xf
    v_dot2c_f32_bf16_dpp v18, v20, v160 row_newbcast:6 row_mask:0xf bank_mask:0xf
    v_dot2c_f32_bf16_dpp v19, v20, v163 row_newbcast:6 row_mask:0xf bank_mask:0xf
    v_dot2c_f32_bf16_dpp v16, v20, v161 row_newbcast:7 row_mask:0xf bank_mask:0xf
    v_dot2c_f32_bf16_dpp v17, v20, v166 row_newbcast:7 row_mask:0xf bank_mask:0xf
    v_dot2c_f32_bf16_dpp v18, v20, v164 row_newbcast:7 row_mask:0xf bank_mask:0xf
    v_dot2c_f32_bf16_dpp v19, v20, v167 row_newbcast:7 row_mask:0xf bank_mask:0xf
    v_dot2c_f32_bf16_dpp v16, v20, v165 row_newbcast:8 row_mask:0xf bank_mask:0xf
    v_dot2c_f32_bf16_dpp v17, v20, v26 row_newbcast:8 row_mask:0xf bank_mask:0xf
    v_dot2c_f32_bf16_dpp v18, v20, v24 row_newbcast:8 row_mask:0xf bank_mask:0xf
    v_dot2c_f32_bf16_dpp v19, v20, v27 row_newbcast:8 row_mask:0xf bank_mask:0xf
    v_dot2c_f32_bf16_dpp v16, v20, v25 row_newbcast:9 row_mask:0xf bank_mask:0xf
    v_dot2c_f32_bf16_dpp v17, v20, v30 row_newbcast:9 row_mask:0xf bank_mask:0xf
    v_dot2c_f32_bf16_dpp v18, v20, v28 row_newbcast:9 row_mask:0xf bank_mask:0xf
    v_dot2c_f32_bf16_dpp v19, v20, v31 row_newbcast:9 row_mask:0xf bank_mask:0xf
    v_dot2c_f32_bf16_dpp v16, v20, v29 row_newbcast:10 row_mask:0xf bank_mask:0xf
    v_dot2c_f32_bf16_dpp v17, v20, v34 row_newbcast:10 row_mask:0xf bank_mask:0xf
    v_dot2c_f32_bf16_dpp v18, v20, v32 row_newbcast:10 row_mask:0xf bank_mask:0xf
    v_dot2c_f32_bf16_dpp v19, v20, v35 row_newbcast:10 row_mask:0xf bank_mask:0xf
    v_dot2c_f32_bf16_dpp v16, v20, v33 row_newbcast:11 row_mask:0xf bank_mask:0xf
    v_dot2c_f32_bf16_dpp v17, v20, v38 row_newbcast:11 row_mask:0xf bank_mask:0xf
    v_dot2c_f32_bf16_dpp v18, v20, v36 row_newbcast:11 row_mask:0xf bank_mask:0xf
    v_dot2c_f32_bf16_dpp v19, v20, v39 row_newbcast:11 row_mask:0xf bank_mask:0xf
    v_dot2c_f32_bf16_dpp v16, v20, v37 row_newbcast:12 row_mask:0xf bank_mask:0xf
    v_dot2c_f32_bf16_dpp v17, v20, v42 row_newbcast:12 row_mask:0xf bank_mask:0xf
    v_dot2c_f32_bf16_dpp v18, v20, v40 row_newbcast:12 row_mask:0xf bank_mask:0xf
    v_dot2c_f32_bf16_dpp v19, v20, v43 row_newbcast:12 row_mask:0xf bank_mask:0xf
    v_dot2c_f32_bf16_dpp v16, v20, v41 row_newbcast:13 row_mask:0xf bank_mask:0xf
    v_dot2c_f32_bf16_dpp v17, v20, v46 row_newbcast:13 row_mask:0xf bank_mask:0xf
    v_dot2c_f32_bf16_dpp v18, v20, v44 row_newbcast:13 row_mask:0xf bank_mask:0xf
    v_dot2c_f32_bf16_dpp v19, v20, v47 row_newbcast:13 row_mask:0xf bank_mask:0xf
    v_dot2c_f32_bf16_dpp v16, v20, v45 row_newbcast:14 row_mask:0xf bank_mask:0xf
    v_dot2c_f32_bf16_dpp v17, v20, v50 row_newbcast:14 row_mask:0xf bank_mask:0xf
    v_dot2c_f32_bf16_dpp v18, v20, v48 row_newbcast:14 row_mask:0xf bank_mask:0xf
    v_dot2c_f32_bf16_dpp v19, v20, v51 row_newbcast:14 row_mask:0xf bank_mask:0xf
    v_dot2c_f32_bf16_dpp v16, v20, v49 row_newbcast:15 row_mask:0xf bank_mask:0xf
    v_dot2c_f32_bf16_dpp v17, v20, v54 row_newbcast:15 row_mask:0xf bank_mask:0xf
    v_dot2c_f32_bf16_dpp v18, v20, v52 row_newbcast:15 row_mask:0xf bank_mask:0xf
    v_dot2c_f32_bf16_dpp v19, v20, v55 row_newbcast:15 row_mask:0xf bank_mask:0xf
    v_dot2c_f32_bf16_dpp v16, v21, v53 row_newbcast:0 row_mask:0xf bank_mask:0xf
    v_dot2c_f32_bf16_dpp v17, v21, v58 row_newbcast:0 row_mask:0xf bank_mask:0xf
    v_dot2c_f32_bf16_dpp v18, v21, v56 row_newbcast:0 row_mask:0xf bank_mask:0xf
    v_dot2c_f32_bf16_dpp v19, v21, v59 row_newbcast:0 row_mask:0xf bank_mask:0xf
    v_dot2c_f32_bf16_dpp v16, v21, v57 row_newbcast:1 row_mask:0xf bank_mask:0xf
    v_dot2c_f32_bf16_dpp v17, v21, v62 row_newbcast:1 row_mask:0xf bank_mask:0xf
    v_dot2c_f32_bf16_dpp v18, v21, v60 row_newbcast:1 row_mask:0xf bank_mask:0xf
    v_dot2c_f32_bf16_dpp v19, v21, v63 row_newbcast:1 row_mask:0xf bank_mask:0xf
    s_nop 1
    v_permlane32_swap_b32 v16, v18
    v_permlane32_swap_b32 v17, v19
    v_add_f32 v16, v16, v18
    v_add_f32 v17, v17, v19
    s_nop 1
    v_permlane16_swap_b32 v16, v17
    v_add_f32 v16, v16, v17
    ds_write_b32 v12, v16 offset:7680
    v_mov_b32 v100, 0
    v_mov_b32 v101, 0
    v_mov_b32 v102, 0
    v_mov_b32 v103, 0
    v_mov_b32 v104, 0
    v_mov_b32 v105, 0
    v_mov_b32 v106, 0
    v_mov_b32 v107, 0
    v_mov_b32 v108, 0
    v_mov_b32 v109, 0
    v_mov_b32 v110, 0
    v_mov_b32 v111, 0
    v_mov_b32 v112, 0
    v_mov_b32 v113, 0
    v_mov_b32 v114, 0
    v_mov_b32 v115, 0
    v_mov_b32 v116, 0
    v_mov_b32 v117, 0
    s_waitcnt lgkmcnt(0)
    s_barrier
    ds_read2st64_b32 v[16:17], v13 offset0:30 offset1:31
    ds_read2st64_b32 v[18:19], v13 offset0:32 offset1:33
    ds_read2st64_b32 v[20:21], v13 offset0:34 offset1:35
    ds_read2st64_b32 v[22:23], v13 offset0:36 offset1:37
    s_waitcnt lgkmcnt(0)
    v_pk_add_f32 v[16:17], v[16:17], v[18:19]
    v_pk_add_f32 v[20:21], v[20:21], v[22:23]
    v_pk_add_f32 v[16:17], v[16:17], v[20:21]
    v_cvt_pk_bf16_f32 v18, v16, v17
    v_lshlrev_b32 v16, 16, v18
    v_and_b32 v17, s78, v18
    v_mul_f32 v18, 0xbfb8aa3b, v16
    v_exp_f32 v18, v18
    s_nop 0
    v_add_f32 v18, 1.0, v18
    v_rcp_f32 v18, v18
    s_nop 0
    v_mul_f32 v16, v16, v18
    v_cvt_pk_bf16_f32 v16, v16, v16
    v_and_b32 v16, s78, v16
    v_mul_f32 v16, v16, v17
    s_nop 1
    v_mov_b32_dpp v17, v16 quad_perm:[1,1,3,3] row_mask:0xf bank_mask:0xf
    v_cvt_pk_bf16_f32 v16, v16, v17
    s_nop 1
    v_dot2c_f32_bf16_dpp v100, v16, v61 quad_perm:[0,0,0,0] row_mask:0xf bank_mask:0xf
    v_dot2c_f32_bf16_dpp v101, v16, v76 quad_perm:[0,0,0,0] row_mask:0xf bank_mask:0xf
    v_dot2c_f32_bf16_dpp v102, v16, v68 quad_perm:[0,0,0,0] row_mask:0xf bank_mask:0xf
    v_dot2c_f32_bf16_dpp v103, v16, v77 quad_perm:[0,0,0,0] row_mask:0xf bank_mask:0xf
    v_dot2c_f32_bf16_dpp v104, v16, v69 quad_perm:[0,0,0,0] row_mask:0xf bank_mask:0xf
    v_dot2c_f32_bf16_dpp v105, v16, v78 quad_perm:[0,0,0,0] row_mask:0xf bank_mask:0xf
    v_dot2c_f32_bf16_dpp v106, v16, v70 quad_perm:[0,0,0,0] row_mask:0xf bank_mask:0xf
    v_dot2c_f32_bf16_dpp v107, v16, v79 quad_perm:[0,0,0,0] row_mask:0xf bank_mask:0xf
    v_dot2c_f32_bf16_dpp v108, v16, v71 quad_perm:[0,0,0,0] row_mask:0xf bank_mask:0xf
    v_dot2c_f32_bf16_dpp v109, v16, v80 quad_perm:[0,0,0,0] row_mask:0xf bank_mask:0xf
    v_dot2c_f32_bf16_dpp v110, v16, v72 quad_perm:[0,0,0,0] row_mask:0xf bank_mask:0xf
    v_dot2c_f32_bf16_dpp v111, v16, v81 quad_perm:[0,0,0,0] row_mask:0xf bank_mask:0xf
    v_dot2c_f32_bf16_dpp v112, v16, v73 quad_perm:[0,0,0,0] row_mask:0xf bank_mask:0xf
    v_dot2c_f32_bf16_dpp v113, v16, v82 quad_perm:[0,0,0,0] row_mask:0xf bank_mask:0xf
    v_dot2c_f32_bf16_dpp v114, v16, v74 quad_perm:[0,0,0,0] row_mask:0xf bank_mask:0xf
    v_dot2c_f32_bf16_dpp v115, v16, v83 quad_perm:[0,0,0,0] row_mask:0xf bank_mask:0xf
    v_dot2c_f32_bf16_dpp v116, v16, v75 quad_perm:[0,0,0,0] row_mask:0xf bank_mask:0xf
    v_dot2c_f32_bf16_dpp v117, v16, v65 quad_perm:[0,0,0,0] row_mask:0xf bank_mask:0xf
    v_dot2c_f32_bf16_dpp v100, v16, v64 quad_perm:[2,2,2,2] row_mask:0xf bank_mask:0xf
    v_dot2c_f32_bf16_dpp v101, v16, v92 quad_perm:[2,2,2,2] row_mask:0xf bank_mask:0xf
    v_dot2c_f32_bf16_dpp v102, v16, v84 quad_perm:[2,2,2,2] row_mask:0xf bank_mask:0xf
    v_dot2c_f32_bf16_dpp v103, v16, v93 quad_perm:[2,2,2,2] row_mask:0xf bank_mask:0xf
    v_dot2c_f32_bf16_dpp v104, v16, v85 quad_perm:[2,2,2,2] row_mask:0xf bank_mask:0xf
    v_dot2c_f32_bf16_dpp v105, v16, v94 quad_perm:[2,2,2,2] row_mask:0xf bank_mask:0xf
    v_dot2c_f32_bf16_dpp v106, v16, v86 quad_perm:[2,2,2,2] row_mask:0xf bank_mask:0xf
    v_dot2c_f32_bf16_dpp v107, v16, v95 quad_perm:[2,2,2,2] row_mask:0xf bank_mask:0xf
    v_dot2c_f32_bf16_dpp v108, v16, v87 quad_perm:[2,2,2,2] row_mask:0xf bank_mask:0xf
    v_dot2c_f32_bf16_dpp v109, v16, v96 quad_perm:[2,2,2,2] row_mask:0xf bank_mask:0xf
    v_dot2c_f32_bf16_dpp v110, v16, v88 quad_perm:[2,2,2,2] row_mask:0xf bank_mask:0xf
    v_dot2c_f32_bf16_dpp v111, v16, v97 quad_perm:[2,2,2,2] row_mask:0xf bank_mask:0xf
    v_dot2c_f32_bf16_dpp v112, v16, v89 quad_perm:[2,2,2,2] row_mask:0xf bank_mask:0xf
    v_dot2c_f32_bf16_dpp v113, v16, v98 quad_perm:[2,2,2,2] row_mask:0xf bank_mask:0xf
    v_dot2c_f32_bf16_dpp v114, v16, v90 quad_perm:[2,2,2,2] row_mask:0xf bank_mask:0xf
    v_dot2c_f32_bf16_dpp v115, v16, v99 quad_perm:[2,2,2,2] row_mask:0xf bank_mask:0xf
    v_dot2c_f32_bf16_dpp v116, v16, v91 quad_perm:[2,2,2,2] row_mask:0xf bank_mask:0xf
    v_dot2c_f32_bf16_dpp v117, v16, v67 quad_perm:[2,2,2,2] row_mask:0xf bank_mask:0xf
    v_permlane32_swap_b32 v100, v104
    v_permlane32_swap_b32 v101, v105
    v_permlane32_swap_b32 v102, v106
    v_permlane32_swap_b32 v103, v107
    v_permlane32_swap_b32 v108, v112
    v_permlane32_swap_b32 v109, v113
    v_permlane32_swap_b32 v110, v114
    v_permlane32_swap_b32 v111, v115
    v_permlane32_swap_b32 v116, v117
    v_add_f32 v100, v100, v104
    v_add_f32 v101, v101, v105
    v_add_f32 v102, v102, v106
    v_add_f32 v103, v103, v107
    v_add_f32 v108, v108, v112
    v_add_f32 v109, v109, v113
    v_add_f32 v110, v110, v114
    v_add_f32 v111, v111, v115
    v_add_f32 v116, v116, v117
    ds_write_b128 v14, v[100:103] offset:11264
    ds_write_b128 v14, v[108:111] offset:12288
    ds_write_b32 v15, v116 offset:13312
    s_waitcnt lgkmcnt(0)
    s_barrier
    s_cmp_ge_u32 s3, 3
    s_cbranch_scc1 L_ffn_end
    s_mov_b32 exec_lo, -1
    s_mov_b32 exec_hi, 0xffff
    ds_read_b128 v[24:27], v5 offset:11264
    ds_read_b128 v[28:31], v5 offset:13568
    ds_read_b128 v[32:35], v5 offset:15872
    ds_read_b128 v[36:39], v5 offset:18176
    ds_read_b128 v[40:43], v5 offset:20480
    ds_read_b128 v[44:47], v5 offset:22784
    ds_read_b128 v[48:51], v5 offset:25088
    ds_read_b128 v[52:55], v5 offset:27392
    s_waitcnt lgkmcnt(0)
    v_pk_add_f32 v[24:25], v[24:25], v[28:29]
    v_pk_add_f32 v[26:27], v[26:27], v[30:31]
    v_pk_add_f32 v[32:33], v[32:33], v[36:37]
    v_pk_add_f32 v[34:35], v[34:35], v[38:39]
    v_pk_add_f32 v[40:41], v[40:41], v[44:45]
    v_pk_add_f32 v[42:43], v[42:43], v[46:47]
    v_pk_add_f32 v[48:49], v[48:49], v[52:53]
    v_pk_add_f32 v[50:51], v[50:51], v[54:55]
    v_pk_add_f32 v[24:25], v[24:25], v[32:33]
    v_pk_add_f32 v[26:27], v[26:27], v[34:35]
    v_pk_add_f32 v[40:41], v[40:41], v[48:49]
    v_pk_add_f32 v[42:43], v[42:43], v[50:51]
    v_pk_add_f32 v[24:25], v[24:25], v[40:41]
    v_pk_add_f32 v[26:27], v[26:27], v[42:43]
    v_min_u32 v24, -2, v24
    v_min_u32 v25, -2, v25
    v_min_u32 v26, -2, v26
    v_min_u32 v27, -2, v27
    buffer_store_dwordx4 v[24:27], v6, s[48:51], s15 offen sc1
    s_nop 1
L_ffn_end:
    s_endpgm
L_helper:
    s_sub_u32 s11, s3, 8
    s_setprio 3
    s_mul_i32 s9, s4, 9
    s_add_u32 s9, s9, s5
    s_mov_b32 s10, 1
    s_mov_b32 s47, s9
    s_cmp_lt_u32 s5, 9
    s_cbranch_scc1 L_role_done
    s_sub_u32 s9, s5, 9
    s_mov_b32 s10, 3
    s_lshl_b32 s47, s9, 3
    s_add_u32 s47, s47, s4
    s_add_u32 s47, s47, 72
    s_cmp_lt_u32 s5, 18
    s_cbranch_scc1 L_role_done
    s_cmp_lt_u32 s5, 23
    s_cselect_b32 s12, 18, 23
    s_cselect_b32 s10, 2, 4
    s_sub_u32 s9, s5, s12
    s_lshl_b32 s9, s9, 3
    s_add_u32 s9, s9, s4
    s_cmp_lt_u32 s9, 36
    s_cselect_b32 s10, s10, 0
L_role_done:
    s_waitcnt lgkmcnt(0)
    s_barrier
    s_load_dwordx2 s[44:45], s[42:43], 0
    s_mov_b32 s48, s42
    s_mov_b32 s49, s43
    s_mov_b32 s50, 0x400000
    s_mov_b32 s51, 0x00020000
    s_cmp_eq_u32 s11, 0
    s_cbranch_scc1 L_ctrl
    s_cmp_eq_u32 s10, 2
    s_cbranch_scc1 L_mod_leis
    s_cmp_lg_u32 s10, 4
    s_cbranch_scc1 L_h23
    s_lshr_b32 s46, s9, 1
    s_and_b32 s79, s9, 1
    s_mov_b32 s70, 1
    s_mov_b32 s71, 0
    s_branch L_mod_go
L_mod_leis:
    s_add_u32 s46, s9, 18
    s_mov_b32 s79, 0
    s_mov_b32 s70, 2
    s_mov_b32 s71, 1
    s_setprio 1
L_fw_19:
    ds_read_b32 v12, v10 offset:0
    s_waitcnt lgkmcnt(0)
    v_readfirstlane_b32 s12, v12
    s_nop 0
    s_cmp_lg_u32 s12, 0
    s_nop 1
    s_cbranch_scc1 L_fwd_20
    s_sleep 8
    s_branch L_fw_19
L_fwd_20:
L_mod_go:
    s_mul_i32 s13, s79, 288
    s_sub_u32 s12, s11, 1
    s_mul_i32 s12, s12, 96
    s_add_u32 s13, s13, s12
    s_lshl_b32 s12, s46, 7
    s_mul_i32 s15, s13, 6912
    s_add_u32 s12, s12, s15
    s_add_u32 s52, s36, s12
    s_addc_u32 s53, s37, 0
    s_sub_u32 s54, 0x3cc000, s12
    s_mov_b32 s55, 0x00020000
    s_lshl_b32 s12, s13, 1
    s_add_u32 s56, s34, s12
    s_addc_u32 s57, s35, 0
    s_sub_u32 s58, 0x480, s12
    s_mov_b32 s59, 0x00020000
    v_lshrrev_b32 v2, 3, v1
    v_and_b32 v3, 7, v1
    v_mul_u32_u24 v4, 24, v2
    v_mul_u32_u24 v2, 82944, v2
    v_lshl_add_u32 v2, v3, 4, v2
    v_mov_b32 v16, 0
    v_mov_b32 v17, 0
    v_mov_b32 v18, 0
    v_mov_b32 v19, 0
    v_mov_b32 v20, 0
    v_mov_b32 v21, 0
    v_mov_b32 v22, 0
    v_mov_b32 v23, 0
    s_nop 2
L_mod_loop:
    buffer_load_dwordx4 v[24:27], v4, s[56:59], 0 offen
    buffer_load_dwordx2 v[28:29], v4, s[56:59], 0 offen offset:16
    s_mov_b32 s15, 0
    buffer_load_dwordx4 v[96:99], v2, s[52:55], s15 offen nt
    s_mov_b32 s15, 6912
    buffer_load_dwordx4 v[100:103], v2, s[52:55], s15 offen nt
    s_mov_b32 s15, 13824
    buffer_load_dwordx4 v[104:107], v2, s[52:55], s15 offen nt
    s_mov_b32 s15, 20736
    buffer_load_dwordx4 v[108:111], v2, s[52:55], s15 offen nt
    s_mov_b32 s15, 27648
    buffer_load_dwordx4 v[112:115], v2, s[52:55], s15 offen nt
    s_mov_b32 s15, 34560
    buffer_load_dwordx4 v[116:119], v2, s[52:55], s15 offen nt
    s_mov_b32 s15, 41472
    buffer_load_dwordx4 v[120:123], v2, s[52:55], s15 offen nt
    s_mov_b32 s15, 48384
    buffer_load_dwordx4 v[124:127], v2, s[52:55], s15 offen nt
    s_mov_b32 s15, 55296
    buffer_load_dwordx4 v[128:131], v2, s[52:55], s15 offen nt
    s_mov_b32 s15, 62208
    buffer_load_dwordx4 v[132:135], v2, s[52:55], s15 offen nt
    s_mov_b32 s15, 69120
    buffer_load_dwordx4 v[136:139], v2, s[52:55], s15 offen nt
    s_mov_b32 s15, 76032
    buffer_load_dwordx4 v[140:143], v2, s[52:55], s15 offen nt
    s_cmp_lg_u32 s71, 0
    s_cbranch_scc1 L_mod_nb
L_mod_nb:
    s_waitcnt vmcnt(12)
    v_lshlrev_b32 v40, 16, v24
    v_and_b32 v41, s78, v24
    v_lshlrev_b32 v42, 16, v25
    v_and_b32 v43, s78, v25
    v_lshlrev_b32 v44, 16, v26
    v_and_b32 v45, s78, v26
    v_lshlrev_b32 v46, 16, v27
    v_and_b32 v47, s78, v27
    v_lshlrev_b32 v48, 16, v28
    v_and_b32 v49, s78, v28
    v_lshlrev_b32 v50, 16, v29
    v_and_b32 v51, s78, v29
    v_mul_f32 v58, 0xbfb8aa3b, v40
    v_mul_f32 v59, 0xbfb8aa3b, v41
    v_mul_f32 v60, 0xbfb8aa3b, v42
    v_mul_f32 v61, 0xbfb8aa3b, v43
    v_mul_f32 v62, 0xbfb8aa3b, v44
    v_mul_f32 v63, 0xbfb8aa3b, v45
    v_mul_f32 v64, 0xbfb8aa3b, v46
    v_mul_f32 v65, 0xbfb8aa3b, v47
    v_mul_f32 v66, 0xbfb8aa3b, v48
    v_mul_f32 v67, 0xbfb8aa3b, v49
    v_mul_f32 v68, 0xbfb8aa3b, v50
    v_mul_f32 v69, 0xbfb8aa3b, v51
    v_exp_f32 v58, v58
    v_exp_f32 v59, v59
    v_exp_f32 v60, v60
    v_exp_f32 v61, v61
    v_exp_f32 v62, v62
    v_exp_f32 v63, v63
    v_exp_f32 v64, v64
    v_exp_f32 v65, v65
    v_exp_f32 v66, v66
    v_exp_f32 v67, v67
    v_exp_f32 v68, v68
    v_exp_f32 v69, v69
    v_add_f32 v58, 1.0, v58
    v_add_f32 v59, 1.0, v59
    v_add_f32 v60, 1.0, v60
    v_add_f32 v61, 1.0, v61
    v_add_f32 v62, 1.0, v62
    v_add_f32 v63, 1.0, v63
    v_add_f32 v64, 1.0, v64
    v_add_f32 v65, 1.0, v65
    v_add_f32 v66, 1.0, v66
    v_add_f32 v67, 1.0, v67
    v_add_f32 v68, 1.0, v68
    v_add_f32 v69, 1.0, v69
    v_rcp_f32 v58, v58
    v_rcp_f32 v59, v59
    v_rcp_f32 v60, v60
    v_rcp_f32 v61, v61
    v_rcp_f32 v62, v62
    v_rcp_f32 v63, v63
    v_rcp_f32 v64, v64
    v_rcp_f32 v65, v65
    v_rcp_f32 v66, v66
    v_rcp_f32 v67, v67
    v_rcp_f32 v68, v68
    v_rcp_f32 v69, v69
    v_mul_f32 v40, v40, v58
    v_mul_f32 v41, v41, v59
    v_mul_f32 v42, v42, v60
    v_mul_f32 v43, v43, v61
    v_mul_f32 v44, v44, v62
    v_mul_f32 v45, v45, v63
    v_mul_f32 v46, v46, v64
    v_mul_f32 v47, v47, v65
    v_mul_f32 v48, v48, v66
    v_mul_f32 v49, v49, v67
    v_mul_f32 v50, v50, v68
    v_mul_f32 v51, v51, v69
    v_cvt_pk_bf16_f32 v24, v40, v41
    v_cvt_pk_bf16_f32 v25, v42, v43
    v_cvt_pk_bf16_f32 v26, v44, v45
    v_cvt_pk_bf16_f32 v27, v46, v47
    v_cvt_pk_bf16_f32 v28, v48, v49
    v_cvt_pk_bf16_f32 v29, v50, v51
    s_waitcnt vmcnt(10)
    v_perm_b32 v33, v100, v96, s76
    v_perm_b32 v100, v100, v96, s77
    v_perm_b32 v96, v101, v97, s76
    v_perm_b32 v101, v101, v97, s77
    v_perm_b32 v97, v102, v98, s76
    v_perm_b32 v102, v102, v98, s77
    v_perm_b32 v98, v103, v99, s76
    v_perm_b32 v103, v103, v99, s77
    v_dot2c_f32_bf16 v16, v24, v33
    v_dot2c_f32_bf16 v17, v24, v100
    v_dot2c_f32_bf16 v18, v24, v96
    v_dot2c_f32_bf16 v19, v24, v101
    v_dot2c_f32_bf16 v20, v24, v97
    v_dot2c_f32_bf16 v21, v24, v102
    v_dot2c_f32_bf16 v22, v24, v98
    v_dot2c_f32_bf16 v23, v24, v103
    s_waitcnt vmcnt(8)
    v_perm_b32 v99, v108, v104, s76
    v_perm_b32 v108, v108, v104, s77
    v_perm_b32 v104, v109, v105, s76
    v_perm_b32 v109, v109, v105, s77
    v_perm_b32 v105, v110, v106, s76
    v_perm_b32 v110, v110, v106, s77
    v_perm_b32 v106, v111, v107, s76
    v_perm_b32 v111, v111, v107, s77
    v_dot2c_f32_bf16 v16, v25, v99
    v_dot2c_f32_bf16 v17, v25, v108
    v_dot2c_f32_bf16 v18, v25, v104
    v_dot2c_f32_bf16 v19, v25, v109
    v_dot2c_f32_bf16 v20, v25, v105
    v_dot2c_f32_bf16 v21, v25, v110
    v_dot2c_f32_bf16 v22, v25, v106
    v_dot2c_f32_bf16 v23, v25, v111
    s_waitcnt vmcnt(6)
    v_perm_b32 v107, v116, v112, s76
    v_perm_b32 v116, v116, v112, s77
    v_perm_b32 v112, v117, v113, s76
    v_perm_b32 v117, v117, v113, s77
    v_perm_b32 v113, v118, v114, s76
    v_perm_b32 v118, v118, v114, s77
    v_perm_b32 v114, v119, v115, s76
    v_perm_b32 v119, v119, v115, s77
    v_dot2c_f32_bf16 v16, v26, v107
    v_dot2c_f32_bf16 v17, v26, v116
    v_dot2c_f32_bf16 v18, v26, v112
    v_dot2c_f32_bf16 v19, v26, v117
    v_dot2c_f32_bf16 v20, v26, v113
    v_dot2c_f32_bf16 v21, v26, v118
    v_dot2c_f32_bf16 v22, v26, v114
    v_dot2c_f32_bf16 v23, v26, v119
    s_waitcnt vmcnt(4)
    v_perm_b32 v115, v124, v120, s76
    v_perm_b32 v124, v124, v120, s77
    v_perm_b32 v120, v125, v121, s76
    v_perm_b32 v125, v125, v121, s77
    v_perm_b32 v121, v126, v122, s76
    v_perm_b32 v126, v126, v122, s77
    v_perm_b32 v122, v127, v123, s76
    v_perm_b32 v127, v127, v123, s77
    v_dot2c_f32_bf16 v16, v27, v115
    v_dot2c_f32_bf16 v17, v27, v124
    v_dot2c_f32_bf16 v18, v27, v120
    v_dot2c_f32_bf16 v19, v27, v125
    v_dot2c_f32_bf16 v20, v27, v121
    v_dot2c_f32_bf16 v21, v27, v126
    v_dot2c_f32_bf16 v22, v27, v122
    v_dot2c_f32_bf16 v23, v27, v127
    s_waitcnt vmcnt(2)
    v_perm_b32 v123, v132, v128, s76
    v_perm_b32 v132, v132, v128, s77
    v_perm_b32 v128, v133, v129, s76
    v_perm_b32 v133, v133, v129, s77
    v_perm_b32 v129, v134, v130, s76
    v_perm_b32 v134, v134, v130, s77
    v_perm_b32 v130, v135, v131, s76
    v_perm_b32 v135, v135, v131, s77
    v_dot2c_f32_bf16 v16, v28, v123
    v_dot2c_f32_bf16 v17, v28, v132
    v_dot2c_f32_bf16 v18, v28, v128
    v_dot2c_f32_bf16 v19, v28, v133
    v_dot2c_f32_bf16 v20, v28, v129
    v_dot2c_f32_bf16 v21, v28, v134
    v_dot2c_f32_bf16 v22, v28, v130
    v_dot2c_f32_bf16 v23, v28, v135
    s_waitcnt vmcnt(0)
    v_perm_b32 v131, v140, v136, s76
    v_perm_b32 v140, v140, v136, s77
    v_perm_b32 v136, v141, v137, s76
    v_perm_b32 v141, v141, v137, s77
    v_perm_b32 v137, v142, v138, s76
    v_perm_b32 v142, v142, v138, s77
    v_perm_b32 v138, v143, v139, s76
    v_perm_b32 v143, v143, v139, s77
    v_dot2c_f32_bf16 v16, v29, v131
    v_dot2c_f32_bf16 v17, v29, v140
    v_dot2c_f32_bf16 v18, v29, v136
    v_dot2c_f32_bf16 v19, v29, v141
    v_dot2c_f32_bf16 v20, v29, v137
    v_dot2c_f32_bf16 v21, v29, v142
    v_dot2c_f32_bf16 v22, v29, v138
    v_dot2c_f32_bf16 v23, v29, v143
    v_add_u32 v2, 1990656, v2
    v_add_u32 v4, 576, v4
    s_sub_u32 s70, s70, 1
    s_cmp_lg_u32 s70, 0
    s_cbranch_scc1 L_mod_loop
    v_permlane32_swap_b32 v16, v20
    v_permlane32_swap_b32 v17, v21
    v_permlane32_swap_b32 v18, v22
    v_permlane32_swap_b32 v19, v23
    v_add_f32 v16, v16, v20
    v_add_f32 v17, v17, v21
    v_add_f32 v18, v18, v22
    v_add_f32 v19, v19, v23
    s_nop 0
    v_permlane16_swap_b32 v16, v18
    v_permlane16_swap_b32 v17, v19
    v_add_f32 v16, v16, v18
    v_add_f32 v17, v17, v19
    s_nop 0
    v_add_f32_dpp v16, v16, v16 row_ror:8 row_mask:0xf bank_mask:0xf
    v_add_f32_dpp v17, v17, v17 row_ror:8 row_mask:0xf bank_mask:0xf
    v_lshlrev_b32 v5, 3, v1
    s_lshl_b32 s12, s11, 9
    v_add_u32 v6, s12, v5
    ds_write_b64 v6, v[16:17] offset:9216
    s_mov_b64 exec, 1
    ds_add_rtn_u32 v12, v10, v11 offset:16
    s_mov_b64 exec, -1
    s_waitcnt lgkmcnt(0)
    s_add_u32 s44, s44, 0x7f4a7c15
    s_addc_u32 s45, s45, 0x9e3779b9
    v_readfirstlane_b32 s12, v12
    s_nop 0
    s_cmp_lg_u32 s12, 2
    s_nop 1
    s_cbranch_scc1 L_mod_done
    ds_read2st64_b64 v[16:19], v5 offset0:19 offset1:20
    ds_read_b64 v[20:21], v5 offset:10752
    v_lshrrev_b32 v4, 4, v1
    s_waitcnt lgkmcnt(0)
    v_pk_add_f32 v[16:17], v[16:17], v[18:19]
    v_pk_add_f32 v[16:17], v[16:17], v[20:21]
    v_mov_b32 v18, s44
    v_mov_b32 v19, s45
    s_cmp_lg_u32 s71, 0
    s_nop 0
    s_cbranch_scc1 L_mod_pub2
    s_cmp_ge_u32 s46, 9
    s_cselect_b32 s12, 2, 0
    s_cselect_b32 s13, 9, 0
    s_add_u32 s12, s12, s79
    s_mul_i32 s12, s12, 4608
    s_sub_u32 s13, s46, s13
    s_lshl_b32 s13, s13, 9
    s_add_u32 s12, s12, s13
    s_add_u32 s12, s12, 0x1000
    v_lshl_add_u32 v4, v3, 2, v4
    v_lshlrev_b32 v4, 4, v4
    s_mov_b32 exec_lo, 0x00ff00ff
    s_mov_b32 exec_hi, 0x00ff00ff
    buffer_store_dwordx4 v[16:19], v4, s[48:51], s12 offen sc1
    s_mov_b64 exec, -1
    s_branch L_mod_done
L_mod_pub2:
    s_mul_i32 s12, s9, 57
    s_lshr_b32 s12, s12, 9
    s_mul_i32 s13, s12, 9
    s_sub_u32 s13, s9, s13
    v_cvt_pk_bf16_f32 v20, v16, v17
    v_lshlrev_b32 v16, 16, v20
    v_and_b32 v17, s78, v20
    v_add_f32 v20, 1.0, v16
    v_add_f32 v21, 1.0, v17
    s_cmp_eq_u32 s12, 2
    s_cselect_b64 s[100:101], -1, 0
    v_cndmask_b32 v16, v16, v20, s[100:101]
    v_cndmask_b32 v17, v17, v21, s[100:101]
    v_cvt_pk_bf16_f32 v16, v16, v17
    v_mov_b32 v17, v16
    s_nop 1
    v_permlane16_swap_b32 v16, v17
    s_lshl_b32 s12, s12, 12
    s_lshl_b32 s13, s13, 8
    s_add_u32 s12, s12, s13
    s_add_u32 s12, s12, 0xa000
    v_lshrrev_b32 v4, 5, v1
    v_lshl_add_u32 v4, v3, 1, v4
    v_lshlrev_b32 v4, 4, v4
    s_mov_b32 exec_lo, 0xff
    s_mov_b32 exec_hi, 0xff
    buffer_store_dwordx4 v[16:19], v4, s[48:51], s12 offen sc1
L_mod_done:
    s_endpgm
L_h23:
    s_waitcnt lgkmcnt(0)
    s_add_u32 s44, s44, 0x7f4a7c15
    s_addc_u32 s45, s45, 0x9e3779b9
    s_cmp_eq_u32 s10, 3
    s_cbranch_scc1 L_wo_w
    s_cmp_eq_u32 s10, 1
    s_cbranch_scc1 L_ysg
    s_endpgm
L_ctrl:
    s_mov_b32 s60, s16
    s_mov_b32 s61, s17
    s_mov_b32 s62, 0x480
    s_mov_b32 s63, 0x00020000
    v_min_u32 v4, 35, v1
    v_lshlrev_b32 v5, 3, v1
    v_lshlrev_b32 v6, 1, v1
    v_lshlrev_b32 v7, 2, v4
    s_mul_i32 s15, s7, 144
    buffer_load_dwordx2 v[34:35], v5, s[60:63], 0 offen
    buffer_load_dwordx2 v[36:37], v5, s[60:63], 0 offen offset:512
    buffer_load_ushort v38, v6, s[60:63], 0 offen offset:1024
    buffer_load_dword v39, v7, s[60:63], s15 offen
    s_mul_i32 s12, s7, 589824
    s_lshl_b32 s13, s6, 8
    s_add_u32 s12, s12, s13
    s_add_u32 s52, s22, s12
    s_addc_u32 s53, s23, 0
    s_sub_u32 s54, 0x480000, s12
    s_mov_b32 s55, 0x00020000
    v_lshrrev_b32 v2, 4, v1
    v_lshlrev_b32 v9, 2, v2
    v_lshlrev_b32 v2, 14, v2
    v_and_b32 v3, 15, v1
    v_lshl_add_u32 v2, v3, 4, v2
    s_mov_b32 s15, 0
    buffer_load_dwordx4 v[96:99], v2, s[52:55], s15 offen nt
    s_mov_b32 s15, 8192
    buffer_load_dwordx4 v[100:103], v2, s[52:55], s15 offen nt
    s_mov_b32 s15, 65536
    buffer_load_dwordx4 v[104:107], v2, s[52:55], s15 offen nt
    s_mov_b32 s15, 73728
    buffer_load_dwordx4 v[108:111], v2, s[52:55], s15 offen nt
    s_mov_b32 s15, 131072
    buffer_load_dwordx4 v[112:115], v2, s[52:55], s15 offen nt
    s_mov_b32 s15, 139264
    buffer_load_dwordx4 v[116:119], v2, s[52:55], s15 offen nt
    s_mov_b32 s15, 196608
    buffer_load_dwordx4 v[120:123], v2, s[52:55], s15 offen nt
    s_mov_b32 s15, 204800
    buffer_load_dwordx4 v[124:127], v2, s[52:55], s15 offen nt
    s_mov_b32 s15, 262144
    buffer_load_dwordx4 v[128:131], v2, s[52:55], s15 offen nt
    s_mov_b32 s15, 270336
    buffer_load_dwordx4 v[132:135], v2, s[52:55], s15 offen nt
    s_mov_b32 s15, 327680
    buffer_load_dwordx4 v[136:139], v2, s[52:55], s15 offen nt
    s_mov_b32 s15, 335872
    buffer_load_dwordx4 v[140:143], v2, s[52:55], s15 offen nt
    s_mov_b32 s15, 393216
    buffer_load_dwordx4 v[144:147], v2, s[52:55], s15 offen nt
    s_mov_b32 s15, 401408
    buffer_load_dwordx4 v[148:151], v2, s[52:55], s15 offen nt
    s_mov_b32 s15, 458752
    buffer_load_dwordx4 v[152:155], v2, s[52:55], s15 offen nt
    s_mov_b32 s15, 466944
    buffer_load_dwordx4 v[156:159], v2, s[52:55], s15 offen nt
    s_mov_b32 s15, 524288
    buffer_load_dwordx4 v[160:163], v2, s[52:55], s15 offen nt
    s_mov_b32 s15, 532480
    buffer_load_dwordx4 v[164:167], v2, s[52:55], s15 offen nt
    v_mov_b32 v24, -1
    v_mov_b32 v25, -1
    v_mov_b32 v26, -1
    v_mov_b32 v27, -1
    v_lshlrev_b32 v5, 4, v1
    s_lshl_b32 s12, s8, 9
    s_add_u32 s12, s12, 0x60000
    v_lshrrev_b32 v6, 5, v1
    v_mul_u32_u24 v6, 327168, v6
    v_add_u32 v6, v6, v5
    s_sub_u32 s12, s12, 327680
    buffer_store_dwordx4 v[24:27], v6, s[48:51], s12 offen sc1
    s_lshl_b32 s12, s8, 4
    s_add_u32 s12, s12, 0x50000
    s_mov_b64 exec, 1
    buffer_store_dwordx4 v[24:27], v10, s[48:51], s12 offen sc1
    s_cmp_lg_u32 s7, 0
    s_cbranch_scc1 L_clr1
    s_lshl_b32 s12, s6, 8
    s_add_u32 s12, s12, 0x54000
    buffer_store_dword v10, v10, s[48:51], s12 offen sc1
L_clr1:
    s_mov_b64 exec, -1
    s_cmp_lg_u32 s10, 1
    s_cbranch_scc1 L_clr2
    s_mov_b32 exec_hi, 0xffff
    v_lshrrev_b32 v6, 2, v1
    v_mul_u32_u24 v6, 4608, v6
    v_and_b32 v8, 3, v1
    v_lshl_add_u32 v6, v8, 4, v6
    s_lshl_b32 s12, s9, 6
    s_add_u32 s12, s12, 0x100000
    buffer_store_dwordx4 v[24:27], v6, s[48:51], s12 offen sc1
    s_add_u32 s12, s12, 55296
    buffer_store_dwordx4 v[24:27], v6, s[48:51], s12 offen sc1
    s_add_u32 s12, s12, 55296
    buffer_store_dwordx4 v[24:27], v6, s[48:51], s12 offen sc1
L_clr2:
    s_mov_b64 exec, -1
    s_cmp_lg_u32 s10, 3
    s_cbranch_scc1 L_clr3
    v_lshrrev_b32 v6, 4, v1
    v_mul_u32_u24 v6, 18432, v6
    v_lshl_add_u32 v6, v3, 4, v6
    s_mul_i32 s12, s4, 2304
    s_lshl_b32 s13, s9, 8
    s_add_u32 s12, s12, s13
    s_add_u32 s12, s12, 0x80000
    buffer_store_dwordx4 v[24:27], v6, s[48:51], s12 offen sc1
L_clr3:
    s_waitcnt vmcnt(20)
    v_lshlrev_b32 v40, 16, v34
    v_and_b32 v41, s78, v34
    v_lshlrev_b32 v42, 16, v35
    v_and_b32 v43, s78, v35
    v_lshlrev_b32 v44, 16, v36
    v_and_b32 v45, s78, v36
    v_lshlrev_b32 v46, 16, v37
    v_and_b32 v47, s78, v37
    v_lshlrev_b32 v48, 16, v38
    v_mul_f32 v61, v40, v40
    v_add_f32 v60, v40, v41
    v_fmac_f32 v61, v41, v41
    v_add_f32 v60, v60, v42
    v_fmac_f32 v61, v42, v42
    v_add_f32 v60, v60, v43
    v_fmac_f32 v61, v43, v43
    v_add_f32 v60, v60, v44
    v_fmac_f32 v61, v44, v44
    v_add_f32 v60, v60, v45
    v_fmac_f32 v61, v45, v45
    v_add_f32 v60, v60, v46
    v_fmac_f32 v61, v46, v46
    v_add_f32 v60, v60, v47
    v_fmac_f32 v61, v47, v47
    v_add_f32 v60, v60, v48
    v_fmac_f32 v61, v48, v48
    s_nop 0
    v_add_f32_dpp v60, v60, v60 row_ror:8 row_mask:0xf bank_mask:0xf
    v_add_f32_dpp v61, v61, v61 row_ror:8 row_mask:0xf bank_mask:0xf
    s_nop 0
    v_add_f32_dpp v60, v60, v60 row_ror:4 row_mask:0xf bank_mask:0xf
    v_add_f32_dpp v61, v61, v61 row_ror:4 row_mask:0xf bank_mask:0xf
    s_nop 0
    v_add_f32_dpp v60, v60, v60 row_ror:2 row_mask:0xf bank_mask:0xf
    v_add_f32_dpp v61, v61, v61 row_ror:2 row_mask:0xf bank_mask:0xf
    s_nop 0
    v_add_f32_dpp v60, v60, v60 row_ror:1 row_mask:0xf bank_mask:0xf
    v_add_f32_dpp v61, v61, v61 row_ror:1 row_mask:0xf bank_mask:0xf
    v_mov_b32 v62, v60
    v_mov_b32 v63, v61
    s_nop 0
    v_permlane16_swap_b32 v60, v62
    v_permlane16_swap_b32 v61, v63
    v_add_f32 v60, v60, v62
    v_add_f32 v61, v61, v63
    v_mov_b32 v62, v60
    v_mov_b32 v63, v61
    s_nop 0
    v_permlane32_swap_b32 v60, v62
    v_permlane32_swap_b32 v61, v63
    v_add_f32 v60, v60, v62
    v_add_f32 v61, v61, v63
    v_mul_f32 v60, 0x3ae38e39, v60
    v_mul_f32 v61, 0x3ae38e39, v61
    v_fma_f32 v61, -v60, v60, v61
    v_max_f32 v61, 0, v61
    v_cvt_pk_bf16_f32 v62, v60, v61
    v_lshlrev_b32 v60, 16, v62
    v_and_b32 v61, s78, v62
    v_add_f32 v61, 0x3727c5ac, v61
    v_cvt_pk_bf16_f32 v61, v61, v61
    v_and_b32 v61, s78, v61
    v_sqrt_f32 v61, v61
    s_nop 0
    v_cvt_pk_bf16_f32 v61, v61, v61
    v_and_b32 v61, s78, v61
    v_rcp_f32 v61, v61
    v_lshlrev_b32 v56, 16, v39
    v_and_b32 v57, s78, v39
    v_sub_f32 v56, v56, v60
    v_sub_f32 v57, v57, v60
    v_cvt_pk_bf16_f32 v58, v56, v57
    v_lshlrev_b32 v56, 16, v58
    v_and_b32 v57, s78, v58
    v_mul_f32 v56, v56, v61
    v_mul_f32 v57, v57, v61
    v_cvt_pk_bf16_f32 v58, v56, v57
    v_lshlrev_b32 v56, 16, v58
    v_and_b32 v57, s78, v58
    s_waitcnt lgkmcnt(0)
    s_add_u32 s44, s44, 0x7f4a7c15
    s_addc_u32 s45, s45, 0x9e3779b9
    s_lshl_b32 s12, s8, 4
    s_add_u32 s12, s12, 0xe000
    s_lshl_b32 s13, s47, 4
    s_add_u32 s13, s13, 0xf000
    v_mov_b32 v8, s13
    v_writelane_b32 v8, s12, 0
    v_mov_b32 v66, s44
    v_mov_b32 v67, s45
    s_bitcmp1_b32 s10, 0
    s_cselect_b32 s12, 3, 1
    v_lshlrev_b32 v5, 4, v4
    s_mul_i32 s64, s7, 576
    s_add_u32 s64, s64, 0x1000
    s_add_u32 s65, s64, 4608
    s_add_u32 s66, s65, 4608
    s_add_u32 s67, s66, 4608
    v_and_b32 v6, 7, v1
    v_lshlrev_b32 v6, 4, v6
    s_lshl_b32 s68, s6, 7
    s_add_u32 s68, s68, 0xe000
    s_waitcnt vmcnt(0)
    s_mov_b32 exec_lo, s12
    s_mov_b32 exec_hi, 0
    buffer_store_dwordx4 v[64:67], v8, s[48:51], 0 offen sc1
    s_mov_b64 exec, -1
    s_mov_b32 s14, 400000
    buffer_load_dwordx4 v[24:27], v5, s[48:51], s64 offen sc1
    buffer_load_dwordx4 v[32:35], v5, s[48:51], s65 offen sc1
    buffer_load_dwordx4 v[40:43], v5, s[48:51], s66 offen sc1
    buffer_load_dwordx4 v[48:51], v5, s[48:51], s67 offen sc1
    buffer_load_dwordx4 v[28:31], v6, s[48:51], s68 offen sc1
    v_perm_b32 v68, v100, v96, s76
    v_perm_b32 v100, v100, v96, s77
    v_perm_b32 v96, v101, v97, s76
    v_perm_b32 v101, v101, v97, s77
    v_perm_b32 v97, v102, v98, s76
    v_perm_b32 v102, v102, v98, s77
    v_perm_b32 v98, v103, v99, s76
    v_perm_b32 v103, v103, v99, s77
    v_perm_b32 v99, v108, v104, s76
    v_perm_b32 v108, v108, v104, s77
    v_perm_b32 v104, v109, v105, s76
    v_perm_b32 v109, v109, v105, s77
    v_perm_b32 v105, v110, v106, s76
    v_perm_b32 v110, v110, v106, s77
    v_perm_b32 v106, v111, v107, s76
    v_perm_b32 v111, v111, v107, s77
    v_perm_b32 v107, v116, v112, s76
    v_perm_b32 v116, v116, v112, s77
    v_perm_b32 v112, v117, v113, s76
    v_perm_b32 v117, v117, v113, s77
    v_perm_b32 v113, v118, v114, s76
    v_perm_b32 v118, v118, v114, s77
    v_perm_b32 v114, v119, v115, s76
    v_perm_b32 v119, v119, v115, s77
    v_perm_b32 v115, v124, v120, s76
    v_perm_b32 v124, v124, v120, s77
    v_perm_b32 v120, v125, v121, s76
    v_perm_b32 v125, v125, v121, s77
    v_perm_b32 v121, v126, v122, s76
    v_perm_b32 v126, v126, v122, s77
    v_perm_b32 v122, v127, v123, s76
    v_perm_b32 v127, v127, v123, s77
    v_perm_b32 v123, v132, v128, s76
    v_perm_b32 v132, v132, v128, s77
    v_perm_b32 v128, v133, v129, s76
    v_perm_b32 v133, v133, v129, s77
    v_perm_b32 v129, v134, v130, s76
    v_perm_b32 v134, v134, v130, s77
    v_perm_b32 v130, v135, v131, s76
    v_perm_b32 v135, v135, v131, s77
    v_perm_b32 v131, v140, v136, s76
    v_perm_b32 v140, v140, v136, s77
    v_perm_b32 v136, v141, v137, s76
    v_perm_b32 v141, v141, v137, s77
    v_perm_b32 v137, v142, v138, s76
    v_perm_b32 v142, v142, v138, s77
    v_perm_b32 v138, v143, v139, s76
    v_perm_b32 v143, v143, v139, s77
    v_perm_b32 v139, v148, v144, s76
    v_perm_b32 v148, v148, v144, s77
    v_perm_b32 v144, v149, v145, s76
    v_perm_b32 v149, v149, v145, s77
    v_perm_b32 v145, v150, v146, s76
    v_perm_b32 v150, v150, v146, s77
    v_perm_b32 v146, v151, v147, s76
    v_perm_b32 v151, v151, v147, s77
    v_perm_b32 v147, v156, v152, s76
    v_perm_b32 v156, v156, v152, s77
    v_perm_b32 v152, v157, v153, s76
    v_perm_b32 v157, v157, v153, s77
    v_perm_b32 v153, v158, v154, s76
    v_perm_b32 v158, v158, v154, s77
    v_perm_b32 v154, v159, v155, s76
    v_perm_b32 v159, v159, v155, s77
    v_perm_b32 v155, v164, v160, s76
    v_perm_b32 v164, v164, v160, s77
    v_perm_b32 v160, v165, v161, s76
    v_perm_b32 v165, v165, v161, s77
    v_perm_b32 v161, v166, v162, s76
    v_perm_b32 v166, v166, v162, s77
    v_perm_b32 v162, v167, v163, s76
    v_perm_b32 v167, v167, v163, s77
    v_mov_b32 v16, 0
    v_mov_b32 v17, 0
    v_mov_b32 v18, 0
    v_mov_b32 v19, 0
    v_mov_b32 v20, 0
    v_mov_b32 v21, 0
    v_mov_b32 v22, 0
    v_mov_b32 v23, 0
    s_nop 1
    s_branch L_h1w_23
L_h1_21:
    buffer_load_dwordx4 v[24:27], v5, s[48:51], s64 offen sc1
    buffer_load_dwordx4 v[32:35], v5, s[48:51], s65 offen sc1
    buffer_load_dwordx4 v[40:43], v5, s[48:51], s66 offen sc1
    buffer_load_dwordx4 v[48:51], v5, s[48:51], s67 offen sc1
    buffer_load_dwordx4 v[28:31], v6, s[48:51], s68 offen sc1
L_h1w_23:
    s_waitcnt vmcnt(0)
    v_cmp_ne_u64 vcc, s[44:45], v[26:27]
    v_cmp_ne_u64 s[12:13], s[44:45], v[34:35]
    s_nop 0
    s_or_b64 vcc, vcc, s[12:13]
    v_cmp_ne_u64 s[12:13], s[44:45], v[42:43]
    s_nop 0
    s_or_b64 vcc, vcc, s[12:13]
    v_cmp_ne_u64 s[12:13], s[44:45], v[50:51]
    s_nop 0
    s_or_b64 vcc, vcc, s[12:13]
    v_cmp_ne_u64 s[12:13], s[44:45], v[30:31]
    s_nop 0
    s_or_b64 vcc, vcc, s[12:13]
    s_cmp_eq_u64 vcc, 0
    s_nop 0
    s_cbranch_scc1 L_h1d_22
    s_sleep 4
    s_sub_u32 s14, s14, 1
    s_cbranch_scc0 L_h1_21
L_h1d_22:
    v_pk_add_f32 v[24:25], v[24:25], v[32:33]
    v_pk_add_f32 v[40:41], v[40:41], v[48:49]
    v_cvt_pk_bf16_f32 v28, v40, v41
    v_lshlrev_b32 v40, 16, v28
    v_and_b32 v41, s78, v28
    v_cvt_pk_bf16_f32 v29, v24, v25
    v_lshlrev_b32 v24, 16, v29
    v_and_b32 v25, s78, v29
    v_add_f32 v40, 1.0, v40
    v_add_f32 v41, 1.0, v41
    v_cvt_pk_bf16_f32 v28, v40, v41
    v_lshlrev_b32 v40, 16, v28
    v_and_b32 v41, s78, v28
    v_mul_f32 v56, v56, v40
    v_mul_f32 v57, v57, v41
    v_cvt_pk_bf16_f32 v28, v56, v57
    v_lshlrev_b32 v56, 16, v28
    v_and_b32 v57, s78, v28
    v_add_f32 v56, v56, v24
    v_add_f32 v57, v57, v25
    v_cvt_pk_bf16_f32 v56, v56, v57
    ds_write_b32 v7, v56 offset:384
    ds_read_b32 v40, v9 offset:384
    ds_read_b32 v41, v9 offset:400
    ds_read_b32 v42, v9 offset:416
    ds_read_b32 v43, v9 offset:432
    ds_read_b32 v44, v9 offset:448
    ds_read_b32 v45, v9 offset:464
    ds_read_b32 v46, v9 offset:480
    ds_read_b32 v47, v9 offset:496
    ds_read_b32 v48, v9 offset:512
    v_lshlrev_b32 v5, 4, v1
    v_lshlrev_b32 v6, 5, v3
    v_lshl_add_u32 v6, v9, 1, v6
    s_lshl_b32 s15, s8, 9
    s_add_u32 s15, s15, 0x10000
    s_waitcnt lgkmcnt(0)
    v_dot2c_f32_bf16 v16, v40, v68
    v_dot2c_f32_bf16 v17, v40, v100
    v_dot2c_f32_bf16 v18, v40, v96
    v_dot2c_f32_bf16 v19, v40, v101
    v_dot2c_f32_bf16 v20, v40, v97
    v_dot2c_f32_bf16 v21, v40, v102
    v_dot2c_f32_bf16 v22, v40, v98
    v_dot2c_f32_bf16 v23, v40, v103
    v_dot2c_f32_bf16 v16, v41, v99
    v_dot2c_f32_bf16 v17, v41, v108
    v_dot2c_f32_bf16 v18, v41, v104
    v_dot2c_f32_bf16 v19, v41, v109
    v_dot2c_f32_bf16 v20, v41, v105
    v_dot2c_f32_bf16 v21, v41, v110
    v_dot2c_f32_bf16 v22, v41, v106
    v_dot2c_f32_bf16 v23, v41, v111
    v_dot2c_f32_bf16 v16, v42, v107
    v_dot2c_f32_bf16 v17, v42, v116
    v_dot2c_f32_bf16 v18, v42, v112
    v_dot2c_f32_bf16 v19, v42, v117
    v_dot2c_f32_bf16 v20, v42, v113
    v_dot2c_f32_bf16 v21, v42, v118
    v_dot2c_f32_bf16 v22, v42, v114
    v_dot2c_f32_bf16 v23, v42, v119
    v_dot2c_f32_bf16 v16, v43, v115
    v_dot2c_f32_bf16 v17, v43, v124
    v_dot2c_f32_bf16 v18, v43, v120
    v_dot2c_f32_bf16 v19, v43, v125
    v_dot2c_f32_bf16 v20, v43, v121
    v_dot2c_f32_bf16 v21, v43, v126
    v_dot2c_f32_bf16 v22, v43, v122
    v_dot2c_f32_bf16 v23, v43, v127
    v_dot2c_f32_bf16 v16, v44, v123
    v_dot2c_f32_bf16 v17, v44, v132
    v_dot2c_f32_bf16 v18, v44, v128
    v_dot2c_f32_bf16 v19, v44, v133
    v_dot2c_f32_bf16 v20, v44, v129
    v_dot2c_f32_bf16 v21, v44, v134
    v_dot2c_f32_bf16 v22, v44, v130
    v_dot2c_f32_bf16 v23, v44, v135
    v_dot2c_f32_bf16 v16, v45, v131
    v_dot2c_f32_bf16 v17, v45, v140
    v_dot2c_f32_bf16 v18, v45, v136
    v_dot2c_f32_bf16 v19, v45, v141
    v_dot2c_f32_bf16 v20, v45, v137
    v_dot2c_f32_bf16 v21, v45, v142
    v_dot2c_f32_bf16 v22, v45, v138
    v_dot2c_f32_bf16 v23, v45, v143
    v_dot2c_f32_bf16 v16, v46, v139
    v_dot2c_f32_bf16 v17, v46, v148
    v_dot2c_f32_bf16 v18, v46, v144
    v_dot2c_f32_bf16 v19, v46, v149
    v_dot2c_f32_bf16 v20, v46, v145
    v_dot2c_f32_bf16 v21, v46, v150
    v_dot2c_f32_bf16 v22, v46, v146
    v_dot2c_f32_bf16 v23, v46, v151
    v_dot2c_f32_bf16 v16, v47, v147
    v_dot2c_f32_bf16 v17, v47, v156
    v_dot2c_f32_bf16 v18, v47, v152
    v_dot2c_f32_bf16 v19, v47, v157
    v_dot2c_f32_bf16 v20, v47, v153
    v_dot2c_f32_bf16 v21, v47, v158
    v_dot2c_f32_bf16 v22, v47, v154
    v_dot2c_f32_bf16 v23, v47, v159
    v_dot2c_f32_bf16 v16, v48, v155
    v_dot2c_f32_bf16 v17, v48, v164
    v_dot2c_f32_bf16 v18, v48, v160
    v_dot2c_f32_bf16 v19, v48, v165
    v_dot2c_f32_bf16 v20, v48, v161
    v_dot2c_f32_bf16 v21, v48, v166
    v_dot2c_f32_bf16 v22, v48, v162
    v_dot2c_f32_bf16 v23, v48, v167
    v_permlane32_swap_b32 v16, v20
    v_permlane32_swap_b32 v17, v21
    v_permlane32_swap_b32 v18, v22
    v_permlane32_swap_b32 v19, v23
    v_add_f32 v16, v16, v20
    v_add_f32 v17, v17, v21
    v_add_f32 v18, v18, v22
    v_add_f32 v19, v19, v23
    s_nop 0
    v_permlane16_swap_b32 v16, v18
    v_permlane16_swap_b32 v17, v19
    v_add_f32 v16, v16, v18
    v_add_f32 v17, v17, v19
    v_min_u32 v16, -2, v16
    v_min_u32 v17, -2, v17
    buffer_store_dwordx2 v[16:17], v6, s[48:51], s15 offen sc1
    s_lshl_b32 s15, s6, 12
    s_add_u32 s15, s15, 0x10000
    v_and_b32 v6, 31, v1
    v_lshlrev_b32 v6, 3, v6
    v_lshrrev_b32 v7, 5, v1
    v_lshl_add_u32 v6, v7, 2, v6
    s_mov_b32 s14, 400000
    s_nop 1
L_qp_24:
    buffer_load_dwordx4 v[24:27], v5, s[48:51], s15 offen offset:0 sc1
    buffer_load_dwordx4 v[28:31], v5, s[48:51], s15 offen offset:1024 sc1
    buffer_load_dwordx4 v[32:35], v5, s[48:51], s15 offen offset:2048 sc1
    buffer_load_dwordx4 v[36:39], v5, s[48:51], s15 offen offset:3072 sc1
    s_waitcnt vmcnt(0)
    v_pk_add_f32 v[24:25], v[24:25], v[28:29]
    v_pk_add_f32 v[26:27], v[26:27], v[30:31]
    v_pk_add_f32 v[32:33], v[32:33], v[36:37]
    v_pk_add_f32 v[34:35], v[34:35], v[38:39]
    v_pk_add_f32 v[24:25], v[24:25], v[32:33]
    v_pk_add_f32 v[26:27], v[26:27], v[34:35]
    s_nop 1
    v_permlane32_swap_b32 v24, v26
    v_permlane32_swap_b32 v25, v27
    v_add_f32 v24, v24, v26
    v_add_f32 v25, v25, v27
    v_max_u32 v26, v24, v25
    v_cvt_pk_bf16_f32 v28, v24, v25
    v_cmp_eq_u32 vcc, -1, v26
    s_nop 0
    s_cmp_eq_u64 vcc, 0
    s_nop 1
    s_cbranch_scc1 L_qpd_25
    s_sleep 4
    s_sub_u32 s14, s14, 1
    s_cbranch_scc0 L_qp_24
L_qpd_25:
    ds_write_b32 v6, v28 offset:64
    ds_write_b32 v10, v11 offset:0
    s_cmp_eq_u32 s10, 3
    s_cbranch_scc1 L_wo
    s_cmp_eq_u32 s10, 2
    s_cbranch_scc1 L_reducer
    s_cmp_eq_u32 s10, 1
    s_cbranch_scc1 L_ysg
    s_endpgm
L_ysg:
    v_min_u32 v2, 35, v1
    s_mul_i32 s12, s11, 36
    v_add_u32 v2, s12, v2
    v_lshlrev_b32 v3, 3, v2
    v_lshlrev_b32 v2, 4, v2
    v_lshlrev_b32 v4, 4, v1
    v_add_u32 v5, 64, v1
    v_min_u32 v5, 71, v5
    v_lshlrev_b32 v5, 4, v5
    s_mov_b32 s68, s16
    s_mov_b32 s69, s17
    s_mov_b32 s70, 0x480
    s_mov_b32 s71, 0x00020000
    s_mov_b32 s52, 0xa000
    s_mov_b32 s55, 0xf480
L_cw_27:
    ds_read_b32 v12, v10 offset:12
    s_waitcnt lgkmcnt(0)
    v_readfirstlane_b32 s12, v12
    s_nop 0
    s_cmp_ge_u32 s12, 8
    s_nop 1
    s_cbranch_scc1 L_cwd_28
    s_sleep 4
    s_branch L_cw_27
L_cwd_28:
    s_mov_b32 s14, 400000
L_ysr0_29:
    buffer_load_dwordx4 v[24:27], v2, s[48:51], s52 offen sc1
    buffer_load_dwordx4 v[28:31], v4, s[48:51], s55 offen sc1
    buffer_load_dwordx4 v[32:35], v5, s[48:51], s55 offen sc1
    buffer_load_dwordx2 v[36:37], v3, s[68:71], 0 offen
    s_waitcnt vmcnt(0)
    v_cmp_ne_u64 vcc, s[44:45], v[26:27]
    v_cmp_ne_u64 s[12:13], s[44:45], v[30:31]
    s_nop 0
    s_or_b64 vcc, vcc, s[12:13]
    v_cmp_ne_u64 s[12:13], s[44:45], v[34:35]
    s_nop 0
    s_or_b64 vcc, vcc, s[12:13]
    s_cmp_eq_u64 vcc, 0
    s_nop 0
    s_cbranch_scc1 L_ysr0d_30
    s_sleep 4
    s_sub_u32 s14, s14, 1
    s_cbranch_scc0 L_ysr0_29
L_ysr0d_30:
    v_lshlrev_b32 v12, 16, v24
    v_and_b32 v13, s78, v24
    v_lshlrev_b32 v14, 16, v25
    v_and_b32 v15, s78, v25
    v_lshlrev_b32 v16, 16, v36
    v_and_b32 v17, s78, v36
    v_lshlrev_b32 v18, 16, v37
    v_and_b32 v19, s78, v37
    s_and_b32 s12, s5, 3
    s_mul_i32 s52, s12, 18432
    s_add_u32 s52, s52, 0x80000
    s_add_u32 s53, s52, 4608
    s_add_u32 s54, s53, 4608
    s_add_u32 s55, s54, 4608
    s_mov_b32 exec_hi, 0xf
    s_mov_b32 s14, 400000
    buffer_load_dwordx4 v[24:27], v2, s[48:51], s52 offen offset:0 sc1
    buffer_load_dwordx4 v[28:31], v2, s[48:51], s52 offen offset:2304 sc1
    buffer_load_dwordx4 v[32:35], v2, s[48:51], s53 offen offset:0 sc1
    buffer_load_dwordx4 v[36:39], v2, s[48:51], s53 offen offset:2304 sc1
    buffer_load_dwordx4 v[40:43], v2, s[48:51], s54 offen offset:0 sc1
    buffer_load_dwordx4 v[44:47], v2, s[48:51], s54 offen offset:2304 sc1
    buffer_load_dwordx4 v[48:51], v2, s[48:51], s55 offen offset:0 sc1
    buffer_load_dwordx4 v[52:55], v2, s[48:51], s55 offen offset:2304 sc1
L_ys_32:
    s_waitcnt vmcnt(0)
    v_pk_add_f32 v[24:25], v[24:25], v[28:29]
    v_pk_add_f32 v[26:27], v[26:27], v[30:31]
    v_pk_add_f32 v[32:33], v[32:33], v[36:37]
    v_pk_add_f32 v[34:35], v[34:35], v[38:39]
    v_pk_add_f32 v[40:41], v[40:41], v[44:45]
    v_pk_add_f32 v[42:43], v[42:43], v[46:47]
    v_pk_add_f32 v[48:49], v[48:49], v[52:53]
    v_pk_add_f32 v[50:51], v[50:51], v[54:55]
    v_pk_add_f32 v[24:25], v[24:25], v[32:33]
    v_pk_add_f32 v[26:27], v[26:27], v[34:35]
    v_pk_add_f32 v[40:41], v[40:41], v[48:49]
    v_pk_add_f32 v[42:43], v[42:43], v[50:51]
    v_pk_add_f32 v[20:21], v[24:25], v[40:41]
    v_pk_add_f32 v[22:23], v[26:27], v[42:43]
    v_max3_u32 v4, v20, v21, v22
    v_max_u32 v4, v4, v23
    v_cmp_eq_u32 vcc, -1, v4
    s_nop 0
    s_cmp_eq_u64 vcc, 0
    s_nop 1
    s_cbranch_scc1 L_ysd_33
    buffer_load_dwordx4 v[24:27], v2, s[48:51], s52 offen offset:0 sc1
    buffer_load_dwordx4 v[28:31], v2, s[48:51], s52 offen offset:2304 sc1
    buffer_load_dwordx4 v[32:35], v2, s[48:51], s53 offen offset:0 sc1
    buffer_load_dwordx4 v[36:39], v2, s[48:51], s53 offen offset:2304 sc1
    buffer_load_dwordx4 v[40:43], v2, s[48:51], s54 offen offset:0 sc1
    buffer_load_dwordx4 v[44:47], v2, s[48:51], s54 offen offset:2304 sc1
    buffer_load_dwordx4 v[48:51], v2, s[48:51], s55 offen offset:0 sc1
    buffer_load_dwordx4 v[52:55], v2, s[48:51], s55 offen offset:2304 sc1
    s_sub_u32 s14, s14, 1
    s_cbranch_scc0 L_ys_32
L_ysd_33:
    v_cvt_pk_bf16_f32 v4, v20, v21
    v_lshlrev_b32 v20, 16, v4
    v_and_b32 v21, s78, v4
    v_cvt_pk_bf16_f32 v5, v22, v23
    v_lshlrev_b32 v22, 16, v5
    v_and_b32 v23, s78, v5
    v_pk_mul_f32 v[20:21], v[20:21], v[12:13]
    v_pk_mul_f32 v[22:23], v[22:23], v[14:15]
    v_cvt_pk_bf16_f32 v4, v20, v21
    v_lshlrev_b32 v20, 16, v4
    v_and_b32 v21, s78, v4
    v_cvt_pk_bf16_f32 v5, v22, v23
    v_lshlrev_b32 v22, 16, v5
    v_and_b32 v23, s78, v5
    v_pk_add_f32 v[20:21], v[20:21], v[16:17]
    v_pk_add_f32 v[22:23], v[22:23], v[18:19]
    v_cvt_pk_bf16_f32 v4, v20, v21
    v_lshlrev_b32 v20, 16, v4
    v_and_b32 v21, s78, v4
    v_cvt_pk_bf16_f32 v5, v22, v23
    v_lshlrev_b32 v22, 16, v5
    v_and_b32 v23, s78, v5
    ds_write_b128 v2, v[20:23] offset:5120
    s_waitcnt lgkmcnt(0)
    s_barrier
    s_waitcnt vmcnt(0)
    s_endpgm
L_wo_w:
    s_setprio 1
L_fw_34:
    ds_read_b32 v12, v10 offset:0
    s_waitcnt lgkmcnt(0)
    v_readfirstlane_b32 s12, v12
    s_nop 0
    s_cmp_lg_u32 s12, 0
    s_nop 1
    s_cbranch_scc1 L_fwd_35
    s_sleep 8
    s_branch L_fw_34
L_fwd_35:
L_wo:
    s_setprio 1
    s_lshl_b32 s46, s4, 2
    s_add_u32 s46, s46, s11
    s_mul_i32 s12, s46, 147456
    s_lshl_b32 s13, s9, 7
    s_add_u32 s12, s12, s13
    s_add_u32 s52, s24, s12
    s_addc_u32 s53, s25, 0
    s_sub_u32 s54, 0x480000, s12
    s_mov_b32 s55, 0x00020000
    v_bfe_u32 v2, v1, 4, 1
    v_mul_u32_u24 v2, 73728, v2
    v_lshrrev_b32 v3, 5, v1
    v_mul_u32_u24 v3, 2304, v3
    v_add_u32 v2, v2, v3
    v_and_b32 v3, 15, v1
    v_lshl_add_u32 v2, v3, 3, v2
    s_mov_b32 s15, 0
    buffer_load_dwordx2 v[96:97], v2, s[52:55], s15 offen offset:0 nt
    buffer_load_dwordx2 v[98:99], v2, s[52:55], s15 offen offset:1152 nt
    s_mov_b32 s15, 4608
    buffer_load_dwordx2 v[100:101], v2, s[52:55], s15 offen offset:0 nt
    buffer_load_dwordx2 v[102:103], v2, s[52:55], s15 offen offset:1152 nt
    s_mov_b32 s15, 9216
    buffer_load_dwordx2 v[104:105], v2, s[52:55], s15 offen offset:0 nt
    buffer_load_dwordx2 v[106:107], v2, s[52:55], s15 offen offset:1152 nt
    s_mov_b32 s15, 13824
    buffer_load_dwordx2 v[108:109], v2, s[52:55], s15 offen offset:0 nt
    buffer_load_dwordx2 v[110:111], v2, s[52:55], s15 offen offset:1152 nt
    s_mov_b32 s15, 18432
    s_waitcnt vmcnt(7)
    buffer_load_dwordx2 v[112:113], v2, s[52:55], s15 offen offset:0 nt
    s_waitcnt vmcnt(7)
    buffer_load_dwordx2 v[114:115], v2, s[52:55], s15 offen offset:1152 nt
    s_mov_b32 s15, 23040
    s_waitcnt vmcnt(7)
    buffer_load_dwordx2 v[116:117], v2, s[52:55], s15 offen offset:0 nt
    s_waitcnt vmcnt(7)
    buffer_load_dwordx2 v[118:119], v2, s[52:55], s15 offen offset:1152 nt
    s_mov_b32 s15, 27648
    s_waitcnt vmcnt(7)
    buffer_load_dwordx2 v[120:121], v2, s[52:55], s15 offen offset:0 nt
    s_waitcnt vmcnt(7)
    buffer_load_dwordx2 v[122:123], v2, s[52:55], s15 offen offset:1152 nt
    s_mov_b32 s15, 32256
    s_waitcnt vmcnt(7)
    buffer_load_dwordx2 v[124:125], v2, s[52:55], s15 offen offset:0 nt
    s_waitcnt vmcnt(7)
    buffer_load_dwordx2 v[126:127], v2, s[52:55], s15 offen offset:1152 nt
    s_mov_b32 s15, 36864
    s_waitcnt vmcnt(7)
    buffer_load_dwordx2 v[128:129], v2, s[52:55], s15 offen offset:0 nt
    s_waitcnt vmcnt(7)
    buffer_load_dwordx2 v[130:131], v2, s[52:55], s15 offen offset:1152 nt
    s_mov_b32 s15, 41472
    s_waitcnt vmcnt(7)
    buffer_load_dwordx2 v[132:133], v2, s[52:55], s15 offen offset:0 nt
    s_waitcnt vmcnt(7)
    buffer_load_dwordx2 v[134:135], v2, s[52:55], s15 offen offset:1152 nt
    s_mov_b32 s15, 46080
    s_waitcnt vmcnt(7)
    buffer_load_dwordx2 v[136:137], v2, s[52:55], s15 offen offset:0 nt
    s_waitcnt vmcnt(7)
    buffer_load_dwordx2 v[138:139], v2, s[52:55], s15 offen offset:1152 nt
    s_mov_b32 s15, 50688
    s_waitcnt vmcnt(7)
    buffer_load_dwordx2 v[140:141], v2, s[52:55], s15 offen offset:0 nt
    s_waitcnt vmcnt(7)
    buffer_load_dwordx2 v[142:143], v2, s[52:55], s15 offen offset:1152 nt
    s_mov_b32 s15, 55296
    s_waitcnt vmcnt(7)
    buffer_load_dwordx2 v[144:145], v2, s[52:55], s15 offen offset:0 nt
    s_waitcnt vmcnt(7)
    buffer_load_dwordx2 v[146:147], v2, s[52:55], s15 offen offset:1152 nt
    s_mov_b32 s15, 59904
    s_waitcnt vmcnt(7)
    buffer_load_dwordx2 v[148:149], v2, s[52:55], s15 offen offset:0 nt
    s_waitcnt vmcnt(7)
    buffer_load_dwordx2 v[150:151], v2, s[52:55], s15 offen offset:1152 nt
    s_mov_b32 s15, 64512
    s_waitcnt vmcnt(7)
    buffer_load_dwordx2 v[152:153], v2, s[52:55], s15 offen offset:0 nt
    s_waitcnt vmcnt(7)
    buffer_load_dwordx2 v[154:155], v2, s[52:55], s15 offen offset:1152 nt
    s_mov_b32 s15, 69120
    s_waitcnt vmcnt(7)
    buffer_load_dwordx2 v[156:157], v2, s[52:55], s15 offen offset:0 nt
    s_waitcnt vmcnt(7)
    buffer_load_dwordx2 v[158:159], v2, s[52:55], s15 offen offset:1152 nt
    v_and_b32 v4, 7, v1
    v_lshlrev_b32 v4, 4, v4
    s_lshl_b32 s15, s46, 7
    s_add_u32 s15, s15, 0xe000
    s_mov_b32 s14, 400000
L_rdyo_36:
    buffer_load_dwordx4 v[28:31], v4, s[48:51], s15 offen sc1
    s_waitcnt vmcnt(0)
    v_cmp_ne_u64 vcc, s[44:45], v[30:31]
    s_nop 0
    s_cmp_eq_u64 vcc, 0
    s_nop 1
    s_cbranch_scc1 L_rdyod_37
    s_sleep 8
    s_sub_u32 s14, s14, 1
    s_cbranch_scc0 L_rdyo_36
L_rdyod_37:
    v_lshrrev_b32 v9, 5, v1
    v_lshlrev_b32 v9, 4, v9
    v_xor_b32 v9, v9, v4
    s_lshl_b32 s65, s46, 7
    s_add_u32 s65, s65, 0x50000
    v_perm_b32 v160, v98, v96, s76
    v_perm_b32 v98, v98, v96, s77
    v_perm_b32 v96, v99, v97, s76
    v_perm_b32 v99, v99, v97, s77
    v_perm_b32 v97, v102, v100, s76
    v_perm_b32 v102, v102, v100, s77
    v_perm_b32 v100, v103, v101, s76
    v_perm_b32 v103, v103, v101, s77
    v_perm_b32 v101, v106, v104, s76
    v_perm_b32 v106, v106, v104, s77
    v_perm_b32 v104, v107, v105, s76
    v_perm_b32 v107, v107, v105, s77
    v_perm_b32 v105, v110, v108, s76
    v_perm_b32 v110, v110, v108, s77
    v_perm_b32 v108, v111, v109, s76
    v_perm_b32 v111, v111, v109, s77
    v_perm_b32 v109, v114, v112, s76
    v_perm_b32 v114, v114, v112, s77
    v_perm_b32 v112, v115, v113, s76
    v_perm_b32 v115, v115, v113, s77
    v_perm_b32 v113, v118, v116, s76
    v_perm_b32 v118, v118, v116, s77
    v_perm_b32 v116, v119, v117, s76
    v_perm_b32 v119, v119, v117, s77
    v_perm_b32 v117, v122, v120, s76
    v_perm_b32 v122, v122, v120, s77
    v_perm_b32 v120, v123, v121, s76
    v_perm_b32 v123, v123, v121, s77
    v_perm_b32 v121, v126, v124, s76
    v_perm_b32 v126, v126, v124, s77
    v_perm_b32 v124, v127, v125, s76
    v_perm_b32 v127, v127, v125, s77
    v_perm_b32 v125, v130, v128, s76
    v_perm_b32 v130, v130, v128, s77
    v_perm_b32 v128, v131, v129, s76
    v_perm_b32 v131, v131, v129, s77
    v_perm_b32 v129, v134, v132, s76
    v_perm_b32 v134, v134, v132, s77
    v_perm_b32 v132, v135, v133, s76
    v_perm_b32 v135, v135, v133, s77
    v_perm_b32 v133, v138, v136, s76
    v_perm_b32 v138, v138, v136, s77
    v_perm_b32 v136, v139, v137, s76
    v_perm_b32 v139, v139, v137, s77
    v_perm_b32 v137, v142, v140, s76
    v_perm_b32 v142, v142, v140, s77
    v_perm_b32 v140, v143, v141, s76
    v_perm_b32 v143, v143, v141, s77
    v_perm_b32 v141, v146, v144, s76
    v_perm_b32 v146, v146, v144, s77
    v_perm_b32 v144, v147, v145, s76
    v_perm_b32 v147, v147, v145, s77
    v_perm_b32 v145, v150, v148, s76
    v_perm_b32 v150, v150, v148, s77
    v_perm_b32 v148, v151, v149, s76
    v_perm_b32 v151, v151, v149, s77
    v_perm_b32 v149, v154, v152, s76
    v_perm_b32 v154, v154, v152, s77
    v_perm_b32 v152, v155, v153, s76
    v_perm_b32 v155, v155, v153, s77
    v_perm_b32 v153, v158, v156, s76
    v_perm_b32 v158, v158, v156, s77
    v_perm_b32 v156, v159, v157, s76
    v_perm_b32 v159, v159, v157, s77
    v_lshlrev_b32 v5, 4, v1
    s_lshl_b32 s15, s46, 12
    s_add_u32 s15, s15, 0x60000
    v_lshrrev_b32 v6, 4, v1
    v_mul_u32_u24 v8, 18432, v6
    v_lshl_add_u32 v6, v3, 2, v6
    v_lshlrev_b32 v6, 2, v6
    s_lshl_b32 s12, s11, 8
    v_add_u32 v6, s12, v6
    v_lshlrev_b32 v7, 4, v3
    v_add_u32 v8, v8, v7
    s_mul_i32 s64, s4, 2304
    s_lshl_b32 s13, s9, 8
    s_add_u32 s64, s64, s13
    s_add_u32 s64, s64, 0x80000
    s_add_u32 s66, s64, 73728
    v_mov_b32 v16, 0
    v_mov_b32 v17, 0
    v_mov_b32 v18, 0
    v_mov_b32 v19, 0
    s_nop 2
L_cw_39:
    ds_read_b32 v12, v10 offset:12
    s_waitcnt lgkmcnt(0)
    v_readfirstlane_b32 s12, v12
    s_nop 0
    s_cmp_ge_u32 s12, 8
    s_nop 1
    s_cbranch_scc1 L_cwd_40
    s_sleep 2
    s_branch L_cw_39
L_cwd_40:
    s_mov_b32 s14, 400000
    buffer_load_dwordx2 v[40:41], v9, s[48:51], s65 offen sc1
    buffer_load_dwordx4 v[24:27], v5, s[48:51], s15 offen offset:0 sc1
    buffer_load_dwordx4 v[28:31], v5, s[48:51], s15 offen offset:1024 sc1
    buffer_load_dwordx4 v[32:35], v5, s[48:51], s15 offen offset:2048 sc1
    buffer_load_dwordx4 v[36:39], v5, s[48:51], s15 offen offset:3072 sc1
L_ox_41:
    s_waitcnt vmcnt(0)
    v_max_f32_dpp v92, v40, v40 quad_perm:[1,0,3,2] row_mask:0xf bank_mask:0xf
    s_nop 1
    v_max_f32_dpp v92, v92, v92 quad_perm:[2,3,0,1] row_mask:0xf bank_mask:0xf
    s_nop 1
    v_max_f32_dpp v92, v92, v92 row_half_mirror row_mask:0xf bank_mask:0xf
    v_max_u32 v93, v40, v41
    v_sub_f32 v40, v40, v92
    v_mul_f32 v40, 0x3fb8aa3b, v40
    v_exp_f32 v40, v40
    v_cmp_eq_u32 s[12:13], -1, v93
    v_mul_f32 v41, v41, v40
    s_nop 1
    v_add_f32_dpp v41, v41, v41 quad_perm:[1,0,3,2] row_mask:0xf bank_mask:0xf
    s_nop 1
    v_add_f32_dpp v41, v41, v41 quad_perm:[2,3,0,1] row_mask:0xf bank_mask:0xf
    s_nop 1
    v_add_f32_dpp v41, v41, v41 row_half_mirror row_mask:0xf bank_mask:0xf
    v_rcp_f32 v41, v41
    s_nop 0
    v_mul_f32 v40, v40, v41
    s_nop 1
    v_mov_b32_dpp v84, v40 row_newbcast:0 row_mask:0xf bank_mask:0xf
    v_mov_b32_dpp v86, v40 row_newbcast:2 row_mask:0xf bank_mask:0xf
    v_mov_b32_dpp v88, v40 row_newbcast:4 row_mask:0xf bank_mask:0xf
    v_mov_b32_dpp v90, v40 row_newbcast:6 row_mask:0xf bank_mask:0xf
    v_pk_mul_f32 v[24:25], v[24:25], v[84:85] op_sel_hi:[1,0]
    v_pk_mul_f32 v[26:27], v[26:27], v[84:85] op_sel_hi:[1,0]
    v_pk_fma_f32 v[24:25], v[28:29], v[86:87], v[24:25] op_sel_hi:[1,0,1]
    v_pk_fma_f32 v[26:27], v[30:31], v[86:87], v[26:27] op_sel_hi:[1,0,1]
    v_pk_fma_f32 v[24:25], v[32:33], v[88:89], v[24:25] op_sel_hi:[1,0,1]
    v_pk_fma_f32 v[26:27], v[34:35], v[88:89], v[26:27] op_sel_hi:[1,0,1]
    v_pk_fma_f32 v[24:25], v[36:37], v[90:91], v[24:25] op_sel_hi:[1,0,1]
    v_pk_fma_f32 v[26:27], v[38:39], v[90:91], v[26:27] op_sel_hi:[1,0,1]
    s_nop 1
    v_permlane32_swap_b32 v24, v26
    v_permlane32_swap_b32 v25, v27
    v_add_f32 v24, v24, v26
    v_add_f32 v25, v25, v27
    v_max_u32 v93, v24, v25
    v_cvt_pk_bf16_f32 v94, v24, v25
    v_cmp_eq_u32 vcc, -1, v93
    s_nop 0
    s_or_b64 vcc, vcc, s[12:13]
    s_cmp_eq_u64 vcc, 0
    s_cbranch_scc1 L_oxd_42
    buffer_load_dwordx2 v[40:41], v9, s[48:51], s65 offen sc1
    buffer_load_dwordx4 v[24:27], v5, s[48:51], s15 offen offset:0 sc1
    buffer_load_dwordx4 v[28:31], v5, s[48:51], s15 offen offset:1024 sc1
    buffer_load_dwordx4 v[32:35], v5, s[48:51], s15 offen offset:2048 sc1
    buffer_load_dwordx4 v[36:39], v5, s[48:51], s15 offen offset:3072 sc1
    s_sub_u32 s14, s14, 1
    s_cbranch_scc0 L_ox_41
L_oxd_42:
L_wo_dry:
    v_dot2c_f32_bf16_dpp v16, v94, v160 row_newbcast:0 row_mask:0xf bank_mask:0xf
    v_dot2c_f32_bf16_dpp v17, v94, v98 row_newbcast:0 row_mask:0xf bank_mask:0xf
    v_dot2c_f32_bf16_dpp v18, v94, v96 row_newbcast:0 row_mask:0xf bank_mask:0xf
    v_dot2c_f32_bf16_dpp v19, v94, v99 row_newbcast:0 row_mask:0xf bank_mask:0xf
    v_dot2c_f32_bf16_dpp v16, v94, v97 row_newbcast:1 row_mask:0xf bank_mask:0xf
    v_dot2c_f32_bf16_dpp v17, v94, v102 row_newbcast:1 row_mask:0xf bank_mask:0xf
    v_dot2c_f32_bf16_dpp v18, v94, v100 row_newbcast:1 row_mask:0xf bank_mask:0xf
    v_dot2c_f32_bf16_dpp v19, v94, v103 row_newbcast:1 row_mask:0xf bank_mask:0xf
    v_dot2c_f32_bf16_dpp v16, v94, v101 row_newbcast:2 row_mask:0xf bank_mask:0xf
    v_dot2c_f32_bf16_dpp v17, v94, v106 row_newbcast:2 row_mask:0xf bank_mask:0xf
    v_dot2c_f32_bf16_dpp v18, v94, v104 row_newbcast:2 row_mask:0xf bank_mask:0xf
    v_dot2c_f32_bf16_dpp v19, v94, v107 row_newbcast:2 row_mask:0xf bank_mask:0xf
    v_dot2c_f32_bf16_dpp v16, v94, v105 row_newbcast:3 row_mask:0xf bank_mask:0xf
    v_dot2c_f32_bf16_dpp v17, v94, v110 row_newbcast:3 row_mask:0xf bank_mask:0xf
    v_dot2c_f32_bf16_dpp v18, v94, v108 row_newbcast:3 row_mask:0xf bank_mask:0xf
    v_dot2c_f32_bf16_dpp v19, v94, v111 row_newbcast:3 row_mask:0xf bank_mask:0xf
    v_dot2c_f32_bf16_dpp v16, v94, v109 row_newbcast:4 row_mask:0xf bank_mask:0xf
    v_dot2c_f32_bf16_dpp v17, v94, v114 row_newbcast:4 row_mask:0xf bank_mask:0xf
    v_dot2c_f32_bf16_dpp v18, v94, v112 row_newbcast:4 row_mask:0xf bank_mask:0xf
    v_dot2c_f32_bf16_dpp v19, v94, v115 row_newbcast:4 row_mask:0xf bank_mask:0xf
    v_dot2c_f32_bf16_dpp v16, v94, v113 row_newbcast:5 row_mask:0xf bank_mask:0xf
    v_dot2c_f32_bf16_dpp v17, v94, v118 row_newbcast:5 row_mask:0xf bank_mask:0xf
    v_dot2c_f32_bf16_dpp v18, v94, v116 row_newbcast:5 row_mask:0xf bank_mask:0xf
    v_dot2c_f32_bf16_dpp v19, v94, v119 row_newbcast:5 row_mask:0xf bank_mask:0xf
    v_dot2c_f32_bf16_dpp v16, v94, v117 row_newbcast:6 row_mask:0xf bank_mask:0xf
    v_dot2c_f32_bf16_dpp v17, v94, v122 row_newbcast:6 row_mask:0xf bank_mask:0xf
    v_dot2c_f32_bf16_dpp v18, v94, v120 row_newbcast:6 row_mask:0xf bank_mask:0xf
    v_dot2c_f32_bf16_dpp v19, v94, v123 row_newbcast:6 row_mask:0xf bank_mask:0xf
    v_dot2c_f32_bf16_dpp v16, v94, v121 row_newbcast:7 row_mask:0xf bank_mask:0xf
    v_dot2c_f32_bf16_dpp v17, v94, v126 row_newbcast:7 row_mask:0xf bank_mask:0xf
    v_dot2c_f32_bf16_dpp v18, v94, v124 row_newbcast:7 row_mask:0xf bank_mask:0xf
    v_dot2c_f32_bf16_dpp v19, v94, v127 row_newbcast:7 row_mask:0xf bank_mask:0xf
    v_dot2c_f32_bf16_dpp v16, v94, v125 row_newbcast:8 row_mask:0xf bank_mask:0xf
    v_dot2c_f32_bf16_dpp v17, v94, v130 row_newbcast:8 row_mask:0xf bank_mask:0xf
    v_dot2c_f32_bf16_dpp v18, v94, v128 row_newbcast:8 row_mask:0xf bank_mask:0xf
    v_dot2c_f32_bf16_dpp v19, v94, v131 row_newbcast:8 row_mask:0xf bank_mask:0xf
    v_dot2c_f32_bf16_dpp v16, v94, v129 row_newbcast:9 row_mask:0xf bank_mask:0xf
    v_dot2c_f32_bf16_dpp v17, v94, v134 row_newbcast:9 row_mask:0xf bank_mask:0xf
    v_dot2c_f32_bf16_dpp v18, v94, v132 row_newbcast:9 row_mask:0xf bank_mask:0xf
    v_dot2c_f32_bf16_dpp v19, v94, v135 row_newbcast:9 row_mask:0xf bank_mask:0xf
    v_dot2c_f32_bf16_dpp v16, v94, v133 row_newbcast:10 row_mask:0xf bank_mask:0xf
    v_dot2c_f32_bf16_dpp v17, v94, v138 row_newbcast:10 row_mask:0xf bank_mask:0xf
    v_dot2c_f32_bf16_dpp v18, v94, v136 row_newbcast:10 row_mask:0xf bank_mask:0xf
    v_dot2c_f32_bf16_dpp v19, v94, v139 row_newbcast:10 row_mask:0xf bank_mask:0xf
    v_dot2c_f32_bf16_dpp v16, v94, v137 row_newbcast:11 row_mask:0xf bank_mask:0xf
    v_dot2c_f32_bf16_dpp v17, v94, v142 row_newbcast:11 row_mask:0xf bank_mask:0xf
    v_dot2c_f32_bf16_dpp v18, v94, v140 row_newbcast:11 row_mask:0xf bank_mask:0xf
    v_dot2c_f32_bf16_dpp v19, v94, v143 row_newbcast:11 row_mask:0xf bank_mask:0xf
    v_dot2c_f32_bf16_dpp v16, v94, v141 row_newbcast:12 row_mask:0xf bank_mask:0xf
    v_dot2c_f32_bf16_dpp v17, v94, v146 row_newbcast:12 row_mask:0xf bank_mask:0xf
    v_dot2c_f32_bf16_dpp v18, v94, v144 row_newbcast:12 row_mask:0xf bank_mask:0xf
    v_dot2c_f32_bf16_dpp v19, v94, v147 row_newbcast:12 row_mask:0xf bank_mask:0xf
    v_dot2c_f32_bf16_dpp v16, v94, v145 row_newbcast:13 row_mask:0xf bank_mask:0xf
    v_dot2c_f32_bf16_dpp v17, v94, v150 row_newbcast:13 row_mask:0xf bank_mask:0xf
    v_dot2c_f32_bf16_dpp v18, v94, v148 row_newbcast:13 row_mask:0xf bank_mask:0xf
    v_dot2c_f32_bf16_dpp v19, v94, v151 row_newbcast:13 row_mask:0xf bank_mask:0xf
    v_dot2c_f32_bf16_dpp v16, v94, v149 row_newbcast:14 row_mask:0xf bank_mask:0xf
    v_dot2c_f32_bf16_dpp v17, v94, v154 row_newbcast:14 row_mask:0xf bank_mask:0xf
    v_dot2c_f32_bf16_dpp v18, v94, v152 row_newbcast:14 row_mask:0xf bank_mask:0xf
    v_dot2c_f32_bf16_dpp v19, v94, v155 row_newbcast:14 row_mask:0xf bank_mask:0xf
    v_dot2c_f32_bf16_dpp v16, v94, v153 row_newbcast:15 row_mask:0xf bank_mask:0xf
    v_dot2c_f32_bf16_dpp v17, v94, v158 row_newbcast:15 row_mask:0xf bank_mask:0xf
    v_dot2c_f32_bf16_dpp v18, v94, v156 row_newbcast:15 row_mask:0xf bank_mask:0xf
    v_dot2c_f32_bf16_dpp v19, v94, v159 row_newbcast:15 row_mask:0xf bank_mask:0xf
    s_nop 1
    v_permlane32_swap_b32 v16, v18
    v_permlane32_swap_b32 v17, v19
    v_add_f32 v16, v16, v18
    v_add_f32 v17, v17, v19
    s_nop 1
    v_permlane16_swap_b32 v16, v17
    v_add_f32 v16, v16, v17
    ds_write_b32 v6, v16 offset:9728
    s_waitcnt lgkmcnt(0)
    s_barrier
    s_cmp_lg_u32 s11, 0
    s_cbranch_scc1 L_wo_end
L_wo_nb:
    ds_read_b128 v[64:67], v7 offset:9728
    ds_read_b128 v[68:71], v7 offset:9984
    ds_read_b128 v[72:75], v7 offset:10240
    ds_read_b128 v[76:79], v7 offset:10496
    s_waitcnt lgkmcnt(0)
    v_pk_add_f32 v[64:65], v[64:65], v[68:69]
    v_pk_add_f32 v[66:67], v[66:67], v[70:71]
    v_pk_add_f32 v[72:73], v[72:73], v[76:77]
    v_pk_add_f32 v[74:75], v[74:75], v[78:79]
    v_pk_add_f32 v[64:65], v[64:65], v[72:73]
    v_pk_add_f32 v[66:67], v[66:67], v[74:75]
    v_min_u32 v64, -2, v64
    v_min_u32 v65, -2, v65
    v_min_u32 v66, -2, v66
    v_min_u32 v67, -2, v67
    buffer_store_dwordx4 v[64:67], v8, s[48:51], s64 offen sc1
    s_nop 1
L_wo_end:
    s_endpgm
L_reducer:
    s_setprio 0
    v_lshlrev_b32 v5, 4, v1
    v_add_u32 v6, 128, v1
    v_min_u32 v6, 143, v6
    v_lshlrev_b32 v6, 4, v6
    s_mov_b32 s15, 0xf000
    v_and_b32 v7, 3, v1
    v_lshlrev_b32 v8, 4, v7
    s_lshl_b32 s64, s9, 6
    s_add_u32 s65, s64, 0xd000
    s_add_u32 s64, s64, 0xa000
L_fw_43:
    ds_read_b32 v12, v10 offset:4
    s_waitcnt lgkmcnt(0)
    v_readfirstlane_b32 s12, v12
    s_nop 0
    s_cmp_lg_u32 s12, 0
    s_nop 1
    s_cbranch_scc1 L_fwd_44
    s_sleep 8
    s_branch L_fw_43
L_fwd_44:
    s_mov_b32 s14, 400000
L_rdyr_45:
    buffer_load_dwordx4 v[32:35], v5, s[48:51], s15 offen offset:0 sc1
    buffer_load_dwordx4 v[36:39], v5, s[48:51], s15 offen offset:1024 sc1
    buffer_load_dwordx4 v[44:47], v6, s[48:51], s15 offen sc1
    buffer_load_dwordx4 v[24:27], v8, s[48:51], s64 offen sc1
    buffer_load_dwordx4 v[28:31], v8, s[48:51], s65 offen sc1
    s_waitcnt vmcnt(0)
    v_cmp_ne_u64 vcc, s[44:45], v[26:27]
    v_cmp_ne_u64 s[12:13], s[44:45], v[30:31]
    s_nop 0
    s_or_b64 vcc, vcc, s[12:13]
    v_cmp_ne_u64 s[12:13], s[44:45], v[34:35]
    s_nop 0
    s_or_b64 vcc, vcc, s[12:13]
    v_cmp_ne_u64 s[12:13], s[44:45], v[38:39]
    s_nop 0
    s_or_b64 vcc, vcc, s[12:13]
    v_cmp_ne_u64 s[12:13], s[44:45], v[46:47]
    s_nop 0
    s_or_b64 vcc, vcc, s[12:13]
    s_cmp_eq_u64 vcc, 0
    s_nop 0
    s_cbranch_scc1 L_rdyrd_46
    s_sleep 8
    s_sub_u32 s14, s14, 1
    s_cbranch_scc0 L_rdyr_45
L_rdyrd_46:
    v_bfe_u32 v12, v1, 3, 1
    v_bfe_u32 v13, v1, 2, 1
    v_lshlrev_b32 v7, 2, v7
    v_lshl_add_u32 v7, v12, 1, v7
    v_add_u32 v7, v7, v13
    v_lshlrev_b32 v64, 1, v7
    s_mov_b32 s64, s16
    s_mov_b32 s65, s17
    s_mov_b32 s66, 0x480
    s_mov_b32 s67, 0x00020000
    s_lshl_b32 s15, s9, 5
    buffer_load_ushort v60, v64, s[64:67], s15 offen
    v_cmp_eq_u32 s[68:69], 1, v12
    v_cmp_eq_u32 s[70:71], 1, v13
    s_nop 0
    v_cndmask_b32 v14, v24, v25, s[68:69]
    v_lshlrev_b32 v15, 16, v14
    v_and_b32 v14, s78, v14
    v_cndmask_b32 v61, v15, v14, s[70:71]
    v_cndmask_b32 v14, v28, v29, s[68:69]
    v_lshlrev_b32 v15, 16, v14
    v_and_b32 v14, s78, v14
    v_cndmask_b32 v62, v15, v14, s[70:71]
    s_waitcnt vmcnt(0)
    v_lshlrev_b32 v60, 16, v60
    s_mov_b32 s64, s38
    s_mov_b32 s65, s39
    s_mov_b32 s66, 0x480
    s_mov_b32 s67, 0x00020000
    s_lshl_b32 s52, s9, 6
    s_add_u32 s52, s52, 0x84800
    s_add_u32 s53, s52, 4608
    s_add_u32 s54, s53, 4608
    s_add_u32 s55, s54, 4608
    s_mul_i32 s56, s9, 4608
    s_add_u32 s56, s56, 0x100000
    s_add_u32 s57, s56, 4096
    v_mov_b32 v112, 0
    v_mov_b32 v113, 0
    v_mov_b32 v114, 0
    v_mov_b32 v115, 0
    v_mov_b32 v132, 0
    v_mov_b32 v133, 0
    v_mov_b32 v134, 0
    v_mov_b32 v135, 0
    v_mov_b32 v152, 0
    v_mov_b32 v153, 0
    v_mov_b32 v154, 0
    v_mov_b32 v155, 0
    s_nop 2
L_cw_48:
    ds_read_b32 v12, v10 offset:12
    s_waitcnt lgkmcnt(0)
    v_readfirstlane_b32 s12, v12
    s_nop 0
    s_cmp_ge_u32 s12, 8
    s_nop 1
    s_cbranch_scc1 L_cwd_49
    s_sleep 4
    s_branch L_cw_48
L_cwd_49:
    s_mov_b32 s14, 400000
L_ysr_50:
    buffer_load_dwordx4 v[24:27], v8, s[48:51], s52 offen offset:0 sc1
    buffer_load_dwordx4 v[28:31], v8, s[48:51], s52 offen offset:2304 sc1
    buffer_load_dwordx4 v[32:35], v8, s[48:51], s53 offen offset:0 sc1
    buffer_load_dwordx4 v[36:39], v8, s[48:51], s53 offen offset:2304 sc1
    buffer_load_dwordx4 v[40:43], v8, s[48:51], s54 offen offset:0 sc1
    buffer_load_dwordx4 v[44:47], v8, s[48:51], s54 offen offset:2304 sc1
    buffer_load_dwordx4 v[48:51], v8, s[48:51], s55 offen offset:0 sc1
    buffer_load_dwordx4 v[52:55], v8, s[48:51], s55 offen offset:2304 sc1
    s_waitcnt vmcnt(0)
    v_pk_add_f32 v[24:25], v[24:25], v[28:29]
    v_pk_add_f32 v[26:27], v[26:27], v[30:31]
    v_pk_add_f32 v[32:33], v[32:33], v[36:37]
    v_pk_add_f32 v[34:35], v[34:35], v[38:39]
    v_pk_add_f32 v[40:41], v[40:41], v[44:45]
    v_pk_add_f32 v[42:43], v[42:43], v[46:47]
    v_pk_add_f32 v[48:49], v[48:49], v[52:53]
    v_pk_add_f32 v[50:51], v[50:51], v[54:55]
    v_pk_add_f32 v[24:25], v[24:25], v[32:33]
    v_pk_add_f32 v[26:27], v[26:27], v[34:35]
    v_pk_add_f32 v[40:41], v[40:41], v[48:49]
    v_pk_add_f32 v[42:43], v[42:43], v[50:51]
    v_pk_add_f32 v[24:25], v[24:25], v[40:41]
    v_pk_add_f32 v[26:27], v[26:27], v[42:43]
    v_max3_u32 v28, v24, v25, v26
    v_max_u32 v28, v28, v27
    v_cmp_eq_u32 vcc, -1, v28
    s_nop 0
    s_cmp_eq_u64 vcc, 0
    s_nop 1
    s_cbranch_scc1 L_ysrd_51
    s_sleep 10
    s_sub_u32 s14, s14, 1
    s_cbranch_scc0 L_ysr_50
L_ysrd_51:
    v_cndmask_b32 v24, v24, v26, s[68:69]
    v_cndmask_b32 v25, v25, v27, s[68:69]
    v_cndmask_b32 v16, v24, v25, s[70:71]
    v_cvt_pk_bf16_f32 v16, v16, v16
    v_and_b32 v16, s78, v16
    v_mul_f32 v16, v16, v61
    v_cvt_pk_bf16_f32 v16, v16, v16
    v_and_b32 v16, s78, v16
    v_add_f32 v60, v60, v16
    v_cvt_pk_bf16_f32 v60, v60, v60
    v_and_b32 v60, s78, v60
    s_lshl_b32 s15, s9, 5
    s_mov_b32 s14, 400000
    buffer_load_dwordx4 v[96:99], v5, s[48:51], s56 offen offset:0 sc1
    buffer_load_dwordx4 v[100:103], v5, s[48:51], s56 offen offset:1024 sc1
    buffer_load_dwordx4 v[104:107], v5, s[48:51], s56 offen offset:2048 sc1
    buffer_load_dwordx4 v[108:111], v5, s[48:51], s56 offen offset:3072 sc1
    s_mov_b32 exec_hi, 0
    buffer_load_dwordx4 v[112:115], v5, s[48:51], s57 offen offset:0 sc1
    s_mov_b32 exec_hi, -1
L_ds_53:
    s_waitcnt vmcnt(0)
    v_pk_add_f32 v[16:17], v[96:97], v[100:101]
    v_pk_add_f32 v[18:19], v[98:99], v[102:103]
    v_pk_add_f32 v[20:21], v[104:105], v[108:109]
    v_pk_add_f32 v[22:23], v[106:107], v[110:111]
    v_pk_add_f32 v[16:17], v[16:17], v[112:113]
    v_pk_add_f32 v[18:19], v[18:19], v[114:115]
    v_pk_add_f32 v[16:17], v[16:17], v[20:21]
    v_pk_add_f32 v[18:19], v[18:19], v[22:23]
    s_nop 0
    v_add_f32_dpp v16, v16, v16 row_ror:8 row_mask:0xf bank_mask:0x3
    v_add_f32_dpp v17, v17, v17 row_ror:8 row_mask:0xf bank_mask:0x3
    s_nop 0
    v_add_f32_dpp v16, v18, v18 row_ror:8 row_mask:0xf bank_mask:0xc
    v_add_f32_dpp v17, v19, v19 row_ror:8 row_mask:0xf bank_mask:0xc
    s_nop 0
    v_add_f32_dpp v16, v16, v16 row_shl:4 row_mask:0xf bank_mask:0x5
    s_nop 1
    v_add_f32_dpp v16, v17, v17 row_shr:4 row_mask:0xf bank_mask:0xa
    v_mov_b32 v17, v16
    s_nop 1
    v_permlane16_swap_b32 v16, v17
    v_add_f32 v16, v16, v17
    v_mov_b32 v17, v16
    s_nop 1
    v_permlane32_swap_b32 v16, v17
    v_add_f32 v16, v16, v17
    v_cmp_eq_u32 vcc, -1, v16
    s_nop 0
    s_cmp_eq_u64 vcc, 0
    s_nop 1
    s_cbranch_scc1 L_dsd_54
    buffer_load_dwordx4 v[96:99], v5, s[48:51], s56 offen offset:0 sc1
    buffer_load_dwordx4 v[100:103], v5, s[48:51], s56 offen offset:1024 sc1
    buffer_load_dwordx4 v[104:107], v5, s[48:51], s56 offen offset:2048 sc1
    buffer_load_dwordx4 v[108:111], v5, s[48:51], s56 offen offset:3072 sc1
    s_mov_b32 exec_hi, 0
    buffer_load_dwordx4 v[112:115], v5, s[48:51], s57 offen offset:0 sc1
    s_mov_b32 exec_hi, -1
    s_sub_u32 s14, s14, 1
    s_cbranch_scc0 L_ds_53
L_dsd_54:
    v_cvt_pk_bf16_f32 v16, v16, v16
    v_and_b32 v16, s78, v16
    v_mul_f32 v16, v16, v62
    v_cvt_pk_bf16_f32 v16, v16, v16
    v_and_b32 v16, s78, v16
    v_add_f32 v16, v60, v16
    v_cvt_pk_bf16_f32 v16, v16, v16
    s_mov_b64 exec, 0xffff
    buffer_store_short v16, v64, s[64:67], s15 offen
    s_cmp_lg_u32 s9, 0
    s_cbranch_scc1 L_red_end
    v_mov_b32 v18, s44
    v_mov_b32 v19, s45
    s_mov_b64 exec, 1
    buffer_store_dwordx2 v[18:19], v10, s[48:51], 0 offen
    s_nop 0
L_red_end:
    s_waitcnt vmcnt(0)
    s_endpgm
L_exit:
    s_endpgm
.section .rodata,"a"
.p2align 6
.amdhsa_kernel adaLN_cond__mha_block_cached__swiglu_ffn__decode_kernel
  .amdhsa_next_free_vgpr 168
  .amdhsa_next_free_sgpr 102
  .amdhsa_accum_offset 168
  .amdhsa_group_segment_fixed_size 0
  .amdhsa_kernarg_size 112
  .amdhsa_user_sgpr_count 2
  .amdhsa_user_sgpr_kernarg_segment_ptr 1
  .amdhsa_system_sgpr_workgroup_id_x 1
  .amdhsa_float_denorm_mode_32 3
.end_amdhsa_kernel
```
